```python
import torch

def _softmax(x, axis=-1):
    return torch.softmax(x, dim=axis)
def _gelu(x):
    return torch.nn.functional.gelu(x, approximate="tanh")
def _silu(x):
    return torch.nn.functional.silu(x)
def _sigmoid(x):
    return torch.sigmoid(x)
def _layernorm(x, axis=-1, eps=1e-5):
    m = x.mean(dim=axis, keepdim=True)
    v = x.var(dim=axis, keepdim=True, unbiased=False)
    return (x - m) / torch.sqrt(v + eps)
def _scatter_add(tgt, idx, src, axis=0):
    return tgt.clone().index_add_(axis, idx, src)
def _segment_sum(src, seg, n):
    out = torch.zeros((n,) + src.shape[1:], dtype=src.dtype)
    return out.index_add_(0, seg, src)
def _pad(x, pw):
    flat = tuple(v for pair in reversed(pw) for v in pair)
    return torch.nn.functional.pad(x, flat)

kernel_name = 'standalone__mpnn_edge_mlp__graph'

def setup_inputs():

    _w = (lambda a: (lambda t: t.to(torch.bfloat16) if t.is_floating_point() else t)(torch.as_tensor(a)))
    N, deg, D, De = 12500, 64, 64, max(0, 1)
    E = N * deg
    return {
        "x": _w((lambda *s: torch.randn(*s, dtype=torch.bfloat16) * 0.05)(N, D)),
        "e_attr": _w((lambda *s: torch.randn(*s, dtype=torch.bfloat16) * 0.4)(E, De)),
        "src": _w((lambda lo, hi, *s: torch.randint(lo, hi, s))(0, N, E).to(torch.int64)),
        "dst": _w((lambda lo, hi, *s: torch.randint(lo, hi, s))(0, N, E).to(torch.int64)),
        "w_msg": _w((lambda *s: torch.randn(*s, dtype=torch.bfloat16) * 0.4)(2 * D + De, D)),
        "w_upd": _w((lambda *s: torch.randn(*s, dtype=torch.bfloat16) * 0.05)(2 * D, D)),
    }

def reference(x, e_attr, src, dst, w_msg, w_upd):
    N, D = x.shape
    m_in = torch.concatenate([x[src], x[dst], e_attr], axis=-1)
    msg = _silu(m_in @ w_msg)
    agg = _segment_sum(msg, dst, N)
    return _silu(torch.concatenate([x, agg], axis=-1) @ w_upd)
```

```asm
; @launch kernel=k1_kernel grid=(252,1,1) block=(512,1,1) lds=90112
; @launch kernel=k2_kernel grid=(256,1,1) block=(1024,1,1) lds=154752
.amdgcn_target "amdgcn-amd-amdhsa--gfx950"
.text
.globl k1_kernel
.p2align 8
.type k1_kernel,@function
k1_kernel:
    s_cmp_ge_u32 s2, 250
    s_cbranch_scc1 K1_EXTRA
    s_load_dwordx8 s[4:11], s[0:1], 0
    s_load_dwordx2 s[12:13], s[0:1], 32
    s_load_dwordx2 s[14:15], s[0:1], 64
    v_lshrrev_b32 v2, 6, v0
    v_and_b32 v1, 63, v0
    v_readfirstlane_b32 s16, v2
    v_subrev_u32 v40, 64, v0
    v_mov_b32 v41, 400
    v_cmp_lt_u32 vcc, v40, v41
    s_mul_i32 s17, s2, 12800
    v_lshlrev_b32 v3, 4, v40
    v_add_u32 v2, s17, v3
    s_cmp_eq_u32 s16, 0
    s_cbranch_scc1 K1_TABLE
    s_mov_b64 exec, vcc
    v_add_u32 v4, 0, v2
    v_lshrrev_b32 v8, 1, v4
    v_add_u32 v5, 6400, v2
    v_lshrrev_b32 v9, 1, v5
    v_mov_b32 v35, 1
    s_movk_i32 s3, -147
    s_waitcnt lgkmcnt(0)
    global_load_dwordx4 v[48:51], v4, s[10:11] nt
    global_load_dwordx4 v[84:87], v5, s[10:11] nt
    s_mul_i32 s18, s2, 16896
    s_add_u32 s18, s18, 4194304
    s_barrier
    global_load_dwordx4 v[52:55], v4, s[8:9] nt
    global_load_dwordx4 v[88:91], v5, s[8:9] nt
    global_load_dwordx2 v[56:57], v8, s[6:7] nt
    global_load_dwordx2 v[92:93], v9, s[6:7] nt
    s_waitcnt vmcnt(5)
    v_mul_u32_u24 v58, 5350, v48
    v_lshrrev_b32 v58, 18, v58
    v_lshlrev_b32 v62, 2, v58
    ds_add_rtn_u32 v66, v62, v35 offset:0
    v_mul_u32_u24 v59, 5350, v49
    v_lshrrev_b32 v59, 18, v59
    v_lshlrev_b32 v63, 2, v59
    ds_add_rtn_u32 v67, v63, v35 offset:0
    v_mul_u32_u24 v60, 5350, v50
    v_lshrrev_b32 v60, 18, v60
    v_lshlrev_b32 v64, 2, v60
    ds_add_rtn_u32 v68, v64, v35 offset:0
    v_mul_u32_u24 v61, 5350, v51
    v_lshrrev_b32 v61, 18, v61
    v_lshlrev_b32 v65, 2, v61
    ds_add_rtn_u32 v69, v65, v35 offset:0
    s_waitcnt vmcnt(4)
    v_mul_u32_u24 v94, 5350, v84
    v_lshrrev_b32 v94, 18, v94
    v_lshlrev_b32 v98, 2, v94
    ds_add_rtn_u32 v102, v98, v35 offset:0
    v_mul_u32_u24 v95, 5350, v85
    v_lshrrev_b32 v95, 18, v95
    v_lshlrev_b32 v99, 2, v95
    ds_add_rtn_u32 v103, v99, v35 offset:0
    v_mul_u32_u24 v96, 5350, v86
    v_lshrrev_b32 v96, 18, v96
    v_lshlrev_b32 v100, 2, v96
    ds_add_rtn_u32 v104, v100, v35 offset:0
    v_mul_u32_u24 v97, 5350, v87
    v_lshrrev_b32 v97, 18, v97
    v_lshlrev_b32 v101, 2, v97
    ds_add_rtn_u32 v105, v101, v35 offset:0
    s_waitcnt lgkmcnt(0)
    s_barrier
    v_mad_u32_u24 v48, v48, 3, 1
    v_mad_i32_i24 v70, v58, s3, v48
    v_lshlrev_b32 v62, 1, v62
    v_mad_u32_u24 v49, v49, 3, 1
    v_mad_i32_i24 v71, v59, s3, v49
    v_lshlrev_b32 v63, 1, v63
    v_mad_u32_u24 v50, v50, 3, 1
    v_mad_i32_i24 v72, v60, s3, v50
    v_lshlrev_b32 v64, 1, v64
    v_mad_u32_u24 v51, v51, 3, 1
    v_mad_i32_i24 v73, v61, s3, v51
    v_lshlrev_b32 v65, 1, v65
    v_mad_u32_u24 v84, v84, 3, 1
    v_mad_i32_i24 v106, v94, s3, v84
    v_lshlrev_b32 v98, 1, v98
    v_mad_u32_u24 v85, v85, 3, 1
    v_mad_i32_i24 v107, v95, s3, v85
    v_lshlrev_b32 v99, 1, v99
    v_mad_u32_u24 v86, v86, 3, 1
    v_mad_i32_i24 v108, v96, s3, v86
    v_lshlrev_b32 v100, 1, v100
    v_mad_u32_u24 v87, v87, 3, 1
    v_mad_i32_i24 v109, v97, s3, v87
    v_lshlrev_b32 v101, 1, v101
    s_barrier
    ds_read_b64 v[74:75], v62 offset:1024
    ds_read_b64 v[76:77], v63 offset:1024
    ds_read_b64 v[78:79], v64 offset:1024
    ds_read_b64 v[80:81], v65 offset:1024
    ds_read_b64 v[110:111], v98 offset:1024
    ds_read_b64 v[112:113], v99 offset:1024
    ds_read_b64 v[114:115], v100 offset:1024
    ds_read_b64 v[116:117], v101 offset:1024
    s_mov_b32 s3, 0xffff0000
    s_waitcnt lgkmcnt(0)
    v_add_u32 v75, v75, v66
    v_lshl_add_u32 v74, v66, 2, v74
    v_add_u32 v77, v77, v67
    v_lshl_add_u32 v76, v67, 2, v76
    v_add_u32 v79, v79, v68
    v_lshl_add_u32 v78, v68, 2, v78
    v_add_u32 v81, v81, v69
    v_lshl_add_u32 v80, v69, 2, v80
    v_add_u32 v111, v111, v102
    v_lshl_add_u32 v110, v102, 2, v110
    v_add_u32 v113, v113, v103
    v_lshl_add_u32 v112, v103, 2, v112
    v_add_u32 v115, v115, v104
    v_lshl_add_u32 v114, v104, 2, v114
    v_add_u32 v117, v117, v105
    v_lshl_add_u32 v116, v105, 2, v116
    s_waitcnt vmcnt(3)
    v_add_u32 v48, 12184, v52
    v_lshrrev_b32 v48, 14, v48
    v_add_u32 v70, v70, v48
    ds_write_b8 v75, v70 offset:3072
    v_add_u32 v49, 12184, v53
    v_lshrrev_b32 v49, 14, v49
    v_add_u32 v71, v71, v49
    ds_write_b8 v77, v71 offset:3072
    v_add_u32 v50, 12184, v54
    v_lshrrev_b32 v50, 14, v50
    v_add_u32 v72, v72, v50
    ds_write_b8 v79, v72 offset:3072
    v_add_u32 v51, 12184, v55
    v_lshrrev_b32 v51, 14, v51
    v_add_u32 v73, v73, v51
    ds_write_b8 v81, v73 offset:3072
    s_waitcnt vmcnt(2)
    v_add_u32 v84, 12184, v88
    v_lshrrev_b32 v84, 14, v84
    v_add_u32 v106, v106, v84
    ds_write_b8 v111, v106 offset:3072
    v_add_u32 v85, 12184, v89
    v_lshrrev_b32 v85, 14, v85
    v_add_u32 v107, v107, v85
    ds_write_b8 v113, v107 offset:3072
    v_add_u32 v86, 12184, v90
    v_lshrrev_b32 v86, 14, v86
    v_add_u32 v108, v108, v86
    ds_write_b8 v115, v108 offset:3072
    v_add_u32 v87, 12184, v91
    v_lshrrev_b32 v87, 14, v87
    v_add_u32 v109, v109, v87
    ds_write_b8 v117, v109 offset:3072
    s_waitcnt vmcnt(1)
    v_lshl_or_b32 v52, v56, 16, v52
    v_and_or_b32 v53, v56, s3, v53
    v_lshl_or_b32 v54, v57, 16, v54
    v_and_or_b32 v55, v57, s3, v55
    ds_write_b32 v74, v52 offset:3072
    ds_write_b32 v76, v53 offset:3072
    ds_write_b32 v78, v54 offset:3072
    ds_write_b32 v80, v55 offset:3072
    s_waitcnt vmcnt(0)
    v_lshl_or_b32 v88, v92, 16, v88
    v_and_or_b32 v89, v92, s3, v89
    v_lshl_or_b32 v90, v93, 16, v90
    v_and_or_b32 v91, v93, s3, v91
    ds_write_b32 v110, v88 offset:3072
    ds_write_b32 v112, v89 offset:3072
    ds_write_b32 v114, v90 offset:3072
    ds_write_b32 v116, v91 offset:3072
    s_mov_b64 exec, -1
    v_add_u32 v41, s18, v3
    v_mov_b32 v42, 152
    v_cmp_lt_u32 vcc, v40, v42
    s_waitcnt lgkmcnt(0)
    s_barrier
    ds_read_b128 v[4:7], v3 offset:3072
    ds_read_b128 v[8:11], v3 offset:10240
    ds_read_b128 v[12:15], v3 offset:17408
    s_waitcnt lgkmcnt(2)
    global_store_dwordx4 v41, v[4:7], s[14:15]
    v_add_u32 v41, 7168, v41
    s_waitcnt lgkmcnt(1)
    global_store_dwordx4 v41, v[8:11], s[14:15]
    v_add_u32 v41, 7168, v41
    s_waitcnt lgkmcnt(0)
    s_cbranch_vccz K1_FIN
    s_mov_b64 exec, vcc
    global_store_dwordx4 v41, v[12:15], s[14:15]
K1_FIN:
    s_endpgm
K1_TABLE:
    v_lshlrev_b32 v4, 4, v1
    v_mov_b32 v36, 0
    v_mov_b32 v37, 0
    v_mov_b32 v38, 0
    v_mov_b32 v39, 0
    ds_write_b128 v4, v[36:39] offset:0
    v_lshrrev_b32 v5, 3, v1
    v_and_b32 v6, 7, v1
    v_xor_b32 v6, v6, v5
    v_lshlrev_b32 v6, 4, v6
    v_lshl_add_u32 v6, v5, 7, v6
    s_mul_i32 s23, s2, 6400
    v_add_u32 v6, s23, v6
    v_add_u32 v14, 4096, v6
    s_mov_b32 m0, 28160
    s_waitcnt lgkmcnt(0)
    s_mov_b32 s24, s4
    s_mov_b32 s25, s5
    s_mov_b32 s26, 1600000
    s_mov_b32 s27, 0x00020000
    buffer_load_dwordx4 v6, s[24:27], 0 offen offset:0 lds
    buffer_load_dwordx4 v6, s[24:27], 0 offen offset:1024 lds
    buffer_load_dwordx4 v6, s[24:27], 0 offen offset:2048 lds
    buffer_load_dwordx4 v6, s[24:27], 0 offen offset:3072 lds
    s_mov_b32 m0, 32256
    s_mov_b32 s28, s12
    s_mov_b32 s29, s13
    s_mov_b32 s30, 16512
    s_mov_b32 s31, 0x00020000
    buffer_load_dwordx4 v14, s[24:27], 0 offen offset:0 lds
    buffer_load_dwordx4 v14, s[24:27], 0 offen offset:1024 lds
    buffer_load_dwordx4 v14, s[24:27], 0 offen offset:2048 lds
    s_mov_b32 m0, 19968
    s_movk_i32 s3, 0x1000
    buffer_load_dwordx4 v4, s[28:31], 0 offen offset:0 lds
    buffer_load_dwordx4 v4, s[28:31], 0 offen offset:1024 lds
    buffer_load_dwordx4 v4, s[28:31], 0 offen offset:2048 lds
    buffer_load_dwordx4 v4, s[28:31], 0 offen offset:3072 lds
    s_mov_b32 m0, 24064
    s_nop 0
    buffer_load_dwordx4 v4, s[28:31], s3 offen offset:0 lds
    buffer_load_dwordx4 v4, s[28:31], s3 offen offset:1024 lds
    buffer_load_dwordx4 v4, s[28:31], s3 offen offset:2048 lds
    buffer_load_dwordx4 v4, s[28:31], s3 offen offset:3072 lds
    s_barrier
    s_add_u32 s32, s14, 4096
    s_addc_u32 s33, s15, 0
    s_mov_b32 s34, 1600000
    s_mov_b32 s35, 0x00020000
    v_lshrrev_b32 v7, 4, v1
    v_bfe_u32 v8, v1, 2, 2
    v_and_b32 v9, 3, v1
    v_lshl_add_u32 v8, v7, 3, v8
    v_lshlrev_b32 v8, 7, v8
    v_lshl_add_u32 v8, v9, 5, v8
    v_and_b32 v10, 15, v1
    v_and_b32 v11, 7, v1
    v_xor_b32 v11, v11, v7
    v_lshlrev_b32 v11, 4, v11
    v_lshl_add_u32 v11, v10, 7, v11
    v_xor_b32 v12, 64, v11
    v_lshlrev_b32 v13, 7, v10
    v_lshl_add_u32 v13, v7, 5, v13
    v_add_u32 v13, s23, v13
    v_add_u32 v15, 4096, v13
    s_mov_b32 s40, 0xbfb8aa3b
    s_mov_b32 s41, 0xbfb8aa3b
    v_cmp_gt_u32 s[42:43], 2, v10
    s_and_b32 s3, s2, 7
    s_lshl_b32 s3, s3, 5
    s_lshr_b32 s44, s2, 3
    s_add_u32 s3, s3, s44
    s_lshl_b32 s3, s3, 2
    s_add_u32 s3, s3, 2097152
    v_lshlrev_b32 v3, 12, v1
    v_add_u32 v3, s3, v3
    s_setprio 3
    s_barrier
    ds_read_b128 v[56:59], v4 offset:0
    s_waitcnt lgkmcnt(0)
    v_add_u32 v60, 3, v56
    v_lshrrev_b32 v60, 2, v60
    v_add_u32 v60, v60, v56
    v_add_u32 v61, 3, v57
    v_lshrrev_b32 v61, 2, v61
    v_add_u32 v61, v61, v57
    v_add_u32 v62, 3, v58
    v_lshrrev_b32 v62, 2, v62
    v_add_u32 v62, v62, v58
    v_add_u32 v63, 3, v59
    v_lshrrev_b32 v63, 2, v63
    v_add_u32 v63, v63, v59
    v_add_u32 v66, v60, v61
    v_add_u32 v67, v66, v62
    v_add_u32 v68, v67, v63
    v_mov_b32 v69, v68
    s_nop 1
    v_add_u32_dpp v69, v69, v69 row_shr:1 row_mask:0xf bank_mask:0xf
    s_nop 1
    v_add_u32_dpp v69, v69, v69 row_shr:2 row_mask:0xf bank_mask:0xf
    s_nop 1
    v_add_u32_dpp v69, v69, v69 row_shr:4 row_mask:0xf bank_mask:0xf
    s_nop 1
    v_add_u32_dpp v69, v69, v69 row_shr:8 row_mask:0xf bank_mask:0xf
    s_nop 1
    v_add_u32_dpp v69, v69, v69 row_bcast:15 row_mask:0xa bank_mask:0xf
    s_nop 1
    v_add_u32_dpp v69, v69, v69 row_bcast:31 row_mask:0xc bank_mask:0xf
    s_nop 1
    v_sub_u32 v72, v69, v68
    v_add_u32 v73, v72, v60
    v_add_u32 v74, v72, v66
    v_add_u32 v75, v72, v67
    v_lshlrev_b32 v60, 2, v72
    v_add_lshl_u32 v61, v72, v56, 2
    v_lshlrev_b32 v62, 2, v73
    v_add_lshl_u32 v63, v73, v57, 2
    v_lshlrev_b32 v64, 2, v74
    v_add_lshl_u32 v65, v74, v58, 2
    v_lshlrev_b32 v66, 2, v75
    v_add_lshl_u32 v67, v75, v59, 2
    v_lshlrev_b32 v5, 5, v1
    ds_write_b128 v5, v[60:63] offset:1024
    ds_write_b128 v5, v[64:67] offset:1040
    s_waitcnt lgkmcnt(0)
    s_barrier
    v_lshl_or_b32 v76, v56, 16, v72
    v_lshl_or_b32 v77, v57, 16, v73
    v_lshl_or_b32 v78, v58, 16, v74
    v_lshl_or_b32 v79, v59, 16, v75
    s_waitcnt vmcnt(0)
    global_store_dword v3, v76, s[14:15] offset:0
    global_store_dword v3, v77, s[14:15] offset:1024
    global_store_dword v3, v78, s[14:15] offset:2048
    global_store_dword v3, v79, s[14:15] offset:3072
    ds_read_b128 v[80:83], v11 offset:28160
    ds_read_b128 v[84:87], v12 offset:28160
    ds_read_b128 v[88:91], v11 offset:30208
    ds_read_b128 v[92:95], v12 offset:30208
    ds_read_b128 v[96:99], v11 offset:32256
    ds_read_b128 v[100:103], v12 offset:32256
    ds_read_b128 v[104:107], v11 offset:34304
    ds_read_b128 v[108:111], v12 offset:34304
    ds_read_b64_tr_b16 v[16:17], v8 offset:19968
    ds_read_b64_tr_b16 v[18:19], v8 offset:20480
    ds_read_b64_tr_b16 v[20:21], v8 offset:24064
    ds_read_b64_tr_b16 v[22:23], v8 offset:24576
    ds_read_b64_tr_b16 v[24:25], v8 offset:19976
    ds_read_b64_tr_b16 v[26:27], v8 offset:20488
    ds_read_b64_tr_b16 v[28:29], v8 offset:24072
    ds_read_b64_tr_b16 v[30:31], v8 offset:24584
    ds_read_b64_tr_b16 v[32:33], v8 offset:19984
    ds_read_b64_tr_b16 v[34:35], v8 offset:20496
    ds_read_b64_tr_b16 v[36:37], v8 offset:24080
    ds_read_b64_tr_b16 v[38:39], v8 offset:24592
    ds_read_b64_tr_b16 v[40:41], v8 offset:19992
    ds_read_b64_tr_b16 v[42:43], v8 offset:20504
    ds_read_b64_tr_b16 v[44:45], v8 offset:24088
    ds_read_b64_tr_b16 v[46:47], v8 offset:24600
    s_waitcnt lgkmcnt(0)
    v_mfma_f32_16x16x32_bf16 v[48:51], v[16:19], v[80:83], 0
    v_mfma_f32_16x16x32_bf16 v[52:55], v[24:27], v[80:83], 0
    v_mfma_f32_16x16x32_bf16 v[56:59], v[32:35], v[80:83], 0
    v_mfma_f32_16x16x32_bf16 v[60:63], v[40:43], v[80:83], 0
    v_mfma_f32_16x16x32_bf16 v[48:51], v[20:23], v[84:87], v[48:51]
    v_mfma_f32_16x16x32_bf16 v[52:55], v[28:31], v[84:87], v[52:55]
    v_mfma_f32_16x16x32_bf16 v[56:59], v[36:39], v[84:87], v[56:59]
    v_mfma_f32_16x16x32_bf16 v[60:63], v[44:47], v[84:87], v[60:63]
    v_mfma_f32_16x16x32_bf16 v[64:67], v[16:19], v[88:91], 0
    v_mfma_f32_16x16x32_bf16 v[68:71], v[24:27], v[88:91], 0
    v_mfma_f32_16x16x32_bf16 v[72:75], v[32:35], v[88:91], 0
    v_mfma_f32_16x16x32_bf16 v[76:79], v[40:43], v[88:91], 0
    v_mfma_f32_16x16x32_bf16 v[64:67], v[20:23], v[92:95], v[64:67]
    v_mfma_f32_16x16x32_bf16 v[68:71], v[28:31], v[92:95], v[68:71]
    v_mfma_f32_16x16x32_bf16 v[72:75], v[36:39], v[92:95], v[72:75]
    v_mfma_f32_16x16x32_bf16 v[76:79], v[44:47], v[92:95], v[76:79]
    v_pk_mul_f32 v[48:49], v[48:49], s[40:41]
    v_pk_mul_f32 v[50:51], v[50:51], s[40:41]
    v_pk_mul_f32 v[52:53], v[52:53], s[40:41]
    v_pk_mul_f32 v[54:55], v[54:55], s[40:41]
    v_pk_mul_f32 v[56:57], v[56:57], s[40:41]
    v_pk_mul_f32 v[58:59], v[58:59], s[40:41]
    v_pk_mul_f32 v[60:61], v[60:61], s[40:41]
    v_pk_mul_f32 v[62:63], v[62:63], s[40:41]
    v_cvt_pk_bf16_f32 v80, v48, v49
    v_cvt_pk_bf16_f32 v81, v50, v51
    v_cvt_pk_bf16_f32 v82, v52, v53
    v_cvt_pk_bf16_f32 v83, v54, v55
    v_cvt_pk_bf16_f32 v84, v56, v57
    v_cvt_pk_bf16_f32 v85, v58, v59
    v_cvt_pk_bf16_f32 v86, v60, v61
    v_cvt_pk_bf16_f32 v87, v62, v63
    buffer_store_dwordx4 v[80:83], v13, s[32:35], 0 offen offset:0
    buffer_store_dwordx4 v[84:87], v13, s[32:35], 0 offen offset:16
    v_mfma_f32_16x16x32_bf16 v[48:51], v[16:19], v[96:99], 0
    v_mfma_f32_16x16x32_bf16 v[52:55], v[24:27], v[96:99], 0
    v_mfma_f32_16x16x32_bf16 v[56:59], v[32:35], v[96:99], 0
    v_mfma_f32_16x16x32_bf16 v[60:63], v[40:43], v[96:99], 0
    v_mfma_f32_16x16x32_bf16 v[48:51], v[20:23], v[100:103], v[48:51]
    v_mfma_f32_16x16x32_bf16 v[52:55], v[28:31], v[100:103], v[52:55]
    v_mfma_f32_16x16x32_bf16 v[56:59], v[36:39], v[100:103], v[56:59]
    v_mfma_f32_16x16x32_bf16 v[60:63], v[44:47], v[100:103], v[60:63]
    v_pk_mul_f32 v[64:65], v[64:65], s[40:41]
    v_pk_mul_f32 v[66:67], v[66:67], s[40:41]
    v_pk_mul_f32 v[68:69], v[68:69], s[40:41]
    v_pk_mul_f32 v[70:71], v[70:71], s[40:41]
    v_pk_mul_f32 v[72:73], v[72:73], s[40:41]
    v_pk_mul_f32 v[74:75], v[74:75], s[40:41]
    v_pk_mul_f32 v[76:77], v[76:77], s[40:41]
    v_pk_mul_f32 v[78:79], v[78:79], s[40:41]
    v_cvt_pk_bf16_f32 v88, v64, v65
    v_cvt_pk_bf16_f32 v89, v66, v67
    v_cvt_pk_bf16_f32 v90, v68, v69
    v_cvt_pk_bf16_f32 v91, v70, v71
    v_cvt_pk_bf16_f32 v92, v72, v73
    v_cvt_pk_bf16_f32 v93, v74, v75
    v_cvt_pk_bf16_f32 v94, v76, v77
    v_cvt_pk_bf16_f32 v95, v78, v79
    buffer_store_dwordx4 v[88:91], v13, s[32:35], 0 offen offset:2048
    buffer_store_dwordx4 v[92:95], v13, s[32:35], 0 offen offset:2064
    v_mfma_f32_16x16x32_bf16 v[64:67], v[16:19], v[104:107], 0
    v_mfma_f32_16x16x32_bf16 v[68:71], v[24:27], v[104:107], 0
    v_mfma_f32_16x16x32_bf16 v[72:75], v[32:35], v[104:107], 0
    v_mfma_f32_16x16x32_bf16 v[76:79], v[40:43], v[104:107], 0
    v_mfma_f32_16x16x32_bf16 v[64:67], v[20:23], v[108:111], v[64:67]
    v_mfma_f32_16x16x32_bf16 v[68:71], v[28:31], v[108:111], v[68:71]
    v_mfma_f32_16x16x32_bf16 v[72:75], v[36:39], v[108:111], v[72:75]
    v_mfma_f32_16x16x32_bf16 v[76:79], v[44:47], v[108:111], v[76:79]
    v_pk_mul_f32 v[48:49], v[48:49], s[40:41]
    v_pk_mul_f32 v[50:51], v[50:51], s[40:41]
    v_pk_mul_f32 v[52:53], v[52:53], s[40:41]
    v_pk_mul_f32 v[54:55], v[54:55], s[40:41]
    v_pk_mul_f32 v[56:57], v[56:57], s[40:41]
    v_pk_mul_f32 v[58:59], v[58:59], s[40:41]
    v_pk_mul_f32 v[60:61], v[60:61], s[40:41]
    v_pk_mul_f32 v[62:63], v[62:63], s[40:41]
    v_cvt_pk_bf16_f32 v96, v48, v49
    v_cvt_pk_bf16_f32 v97, v50, v51
    v_cvt_pk_bf16_f32 v98, v52, v53
    v_cvt_pk_bf16_f32 v99, v54, v55
    v_cvt_pk_bf16_f32 v100, v56, v57
    v_cvt_pk_bf16_f32 v101, v58, v59
    v_cvt_pk_bf16_f32 v102, v60, v61
    v_cvt_pk_bf16_f32 v103, v62, v63
    buffer_store_dwordx4 v[96:99], v15, s[32:35], 0 offen offset:0
    buffer_store_dwordx4 v[100:103], v15, s[32:35], 0 offen offset:16
    s_nop 7
    v_pk_mul_f32 v[64:65], v[64:65], s[40:41]
    v_pk_mul_f32 v[66:67], v[66:67], s[40:41]
    v_pk_mul_f32 v[68:69], v[68:69], s[40:41]
    v_pk_mul_f32 v[70:71], v[70:71], s[40:41]
    v_pk_mul_f32 v[72:73], v[72:73], s[40:41]
    v_pk_mul_f32 v[74:75], v[74:75], s[40:41]
    v_pk_mul_f32 v[76:77], v[76:77], s[40:41]
    v_pk_mul_f32 v[78:79], v[78:79], s[40:41]
    v_cvt_pk_bf16_f32 v104, v64, v65
    v_cvt_pk_bf16_f32 v105, v66, v67
    v_cvt_pk_bf16_f32 v106, v68, v69
    v_cvt_pk_bf16_f32 v107, v70, v71
    v_cvt_pk_bf16_f32 v108, v72, v73
    v_cvt_pk_bf16_f32 v109, v74, v75
    v_cvt_pk_bf16_f32 v110, v76, v77
    v_cvt_pk_bf16_f32 v111, v78, v79
    s_mov_b64 exec, s[42:43]
    buffer_store_dwordx4 v[104:107], v15, s[32:35], 0 offen offset:2048
    buffer_store_dwordx4 v[108:111], v15, s[32:35], 0 offen offset:2064
    s_mov_b64 exec, -1
    s_barrier
    s_endpgm
K1_EXTRA:
    s_cmp_ge_u32 s2, 252
    s_cbranch_scc1 K1_END
    s_load_dwordx4 s[8:11], s[0:1], 32
    s_load_dwordx2 s[14:15], s[0:1], 64
    v_lshrrev_b32 v2, 6, v0
    v_and_b32 v1, 63, v0
    v_readfirstlane_b32 s16, v2
    s_waitcnt lgkmcnt(0)
    s_mov_b32 s20, s8
    s_mov_b32 s21, s9
    s_mov_b32 s22, 16512
    s_mov_b32 s23, 0x00020000
    s_mov_b32 s24, s10
    s_mov_b32 s25, s11
    s_mov_b32 s26, 16384
    s_mov_b32 s27, 0x00020000
    s_sub_u32 s3, s2, 250
    s_mul_i32 s3, s3, 8
    s_add_u32 s16, s16, s3
    s_cmp_eq_u32 s16, 0
    s_cbranch_scc1 K1_CONST
    s_sub_u32 s17, s16, 1
K1_FRAG:
    s_cmp_gt_u32 s17, 11
    s_cbranch_scc1 K1_END
    s_lshr_b32 s18, s17, 2
    s_and_b32 s19, s17, 3
    v_and_b32 v3, 15, v1
    v_lshrrev_b32 v4, 4, v1
    v_lshlrev_b32 v4, 10, v4
    s_lshl_b32 s3, s19, 4
    v_add_u32 v5, s3, v3
    v_lshrrev_b32 v6, 2, v3
    v_and_b32 v7, 3, v3
    v_lshl_add_u32 v6, v6, 4, v7
    s_lshl_b32 s3, s19, 2
    v_add_u32 v6, s3, v6
    s_cmp_ge_u32 s18, 1
    s_cselect_b64 s[30:31], -1, 0
    v_cndmask_b32 v5, v5, v6, s[30:31]
    v_lshl_add_u32 v4, v5, 1, v4
    s_cmp_eq_u32 s18, 0
    s_cselect_b32 s28, s8, s10
    s_cselect_b32 s29, s9, s11
    s_movk_i32 s30, 0x4000
    s_mov_b32 s31, 0x00020000
    s_cmp_eq_u32 s18, 1
    s_cselect_b32 s3, 0, 0x2000
    s_add_u32 s4, s3, 0x1000
    buffer_load_ushort v16, v4, s[28:31], s3 offen offset:0
    buffer_load_ushort v17, v4, s[28:31], s3 offen offset:128
    buffer_load_ushort v18, v4, s[28:31], s3 offen offset:256
    buffer_load_ushort v19, v4, s[28:31], s3 offen offset:384
    buffer_load_ushort v20, v4, s[28:31], s3 offen offset:512
    buffer_load_ushort v21, v4, s[28:31], s3 offen offset:640
    buffer_load_ushort v22, v4, s[28:31], s3 offen offset:768
    buffer_load_ushort v23, v4, s[28:31], s3 offen offset:896
    buffer_load_ushort v24, v4, s[28:31], s4 offen offset:0
    buffer_load_ushort v25, v4, s[28:31], s4 offen offset:128
    buffer_load_ushort v26, v4, s[28:31], s4 offen offset:256
    buffer_load_ushort v27, v4, s[28:31], s4 offen offset:384
    buffer_load_ushort v28, v4, s[28:31], s4 offen offset:512
    buffer_load_ushort v29, v4, s[28:31], s4 offen offset:640
    buffer_load_ushort v30, v4, s[28:31], s4 offen offset:768
    buffer_load_ushort v31, v4, s[28:31], s4 offen offset:896
    s_add_u32 s32, s14, 2629632
    s_addc_u32 s33, s15, 0
    s_mov_b32 s34, 24576
    s_mov_b32 s35, 0x00020000
    s_lshl_b32 s3, s17, 11
    v_lshlrev_b32 v2, 4, v1
    s_waitcnt vmcnt(0)
    v_lshl_or_b32 v8, v17, 16, v16
    v_lshl_or_b32 v9, v19, 16, v18
    v_lshl_or_b32 v10, v21, 16, v20
    v_lshl_or_b32 v11, v23, 16, v22
    v_lshl_or_b32 v12, v25, 16, v24
    v_lshl_or_b32 v13, v27, 16, v26
    v_lshl_or_b32 v14, v29, 16, v28
    v_lshl_or_b32 v15, v31, 16, v30
    buffer_store_dwordx4 v[8:11], v2, s[32:35], s3 offen
    buffer_store_dwordx4 v[12:15], v2, s[32:35], s3 offen offset:1024
    s_add_u32 s17, s17, 15
    s_branch K1_FRAG
K1_CONST:
    v_and_b32 v8, 31, v1
    v_lshlrev_b32 v9, 1, v8
    s_movk_i32 s3, 0x4000
    buffer_load_ushort v24, v9, s[20:23], s3 offen
    buffer_load_ushort v25, v9, s[20:23], s3 offen offset:64
    v_lshrrev_b32 v11, 5, v1
    v_lshlrev_b32 v47, 3, v8
    v_lshlrev_b32 v12, 3, v11
    v_sub_u32 v12, v8, v12
    v_and_b32 v13, 1, v12
    v_lshlrev_b32 v13, 4, v13
    v_mov_b32 v14, 0x3f80
    v_lshlrev_b32 v13, v13, v14
    v_ashrrev_i32 v12, 1, v12
    v_cmp_eq_u32 s[60:61], 0, v12
    v_cmp_eq_u32 s[62:63], 8, v12
    v_cmp_eq_u32 s[64:65], 1, v12
    v_cmp_eq_u32 s[66:67], 9, v12
    v_cmp_eq_u32 s[68:69], 2, v12
    v_cmp_eq_u32 s[70:71], 10, v12
    v_cmp_eq_u32 s[72:73], 3, v12
    v_cmp_eq_u32 s[74:75], 11, v12
    v_cndmask_b32 v32, 0, v13, s[60:61]
    v_cndmask_b32 v36, 0, v13, s[62:63]
    v_cndmask_b32 v33, 0, v13, s[64:65]
    v_cndmask_b32 v37, 0, v13, s[66:67]
    v_cndmask_b32 v34, 0, v13, s[68:69]
    v_cndmask_b32 v38, 0, v13, s[70:71]
    v_cndmask_b32 v35, 0, v13, s[72:73]
    v_cndmask_b32 v39, 0, v13, s[74:75]
    v_bfe_u32 v12, v8, 2, 1
    v_and_b32 v13, 1, v8
    v_lshl_or_b32 v14, v12, 1, v13
    v_lshlrev_b32 v15, 1, v11
    v_sub_u32 v15, v14, v15
    v_cmp_eq_u32 s[60:61], 0, v15
    v_cmp_eq_u32 s[62:63], 1, v15
    v_mov_b32 v26, 0x3f803f80
    s_nop 0
    v_cndmask_b32 v56, 0, v26, s[60:61]
    v_cndmask_b32 v57, 0, v26, s[62:63]
    v_bfe_u32 v15, v8, 1, 1
    v_lshrrev_b32 v26, 3, v8
    v_lshl_or_b32 v27, v26, 1, v15
    v_lshl_or_b32 v49, v27, 2, 2
    v_lshl_or_b32 v27, v14, 3, v27
    v_and_b32 v28, 3, v27
    v_lshrrev_b32 v27, 2, v27
    v_lshl_or_b32 v27, v28, 3, v27
    v_and_b32 v28, 7, v8
    v_xor_b32 v28, v28, v11
    v_lshlrev_b32 v28, 4, v28
    v_lshl_add_u32 v40, v27, 7, v28
    v_xor_b32 v41, 32, v40
    v_xor_b32 v42, 64, v40
    v_xor_b32 v43, 96, v40
    v_lshlrev_b32 v48, 1, v1
    v_and_b32 v48, 16, v48
    v_lshrrev_b32 v7, 4, v1
    s_mov_b32 s3, 75840
    v_lshl_add_u32 v44, v7, 3, s3
    v_lshl_add_u32 v45, v14, 3, s3
    s_mov_b32 s3, 75844
    v_lshl_add_u32 v46, v11, 4, s3
    v_and_b32 v5, 15, v1
    v_and_b32 v2, 7, v1
    v_xor_b32 v2, v2, v7
    v_lshlrev_b32 v2, 4, v2
    v_lshl_add_u32 v2, v5, 7, v2
    v_add_u32 v52, 105600, v2
    v_lshlrev_b32 v3, 4, v1
    v_add_u32 v53, 89216, v3
    v_mul_u32_u24 v54, 528, v5
    v_lshl_add_u32 v54, v7, 5, v54
    v_mul_u32_u24 v55, 12, v5
    v_mul_u32_u24 v62, 448, v14
    s_mov_b32 s3, 53440
    v_add3_u32 v62, v62, v49, s3
    v_mul_u32_u24 v63, 1056, v11
    v_add_u32 v63, v63, v47
    s_mov_b32 s3, 0xbfb8aa3b
    v_cmp_gt_u32 s[60:61], 32, v1
    v_mov_b32 v59, 0
    v_mov_b32 v61, 0
    s_waitcnt vmcnt(0)
    v_lshlrev_b32 v24, 16, v24
    v_mul_f32 v24, s3, v24
    v_cvt_pk_bf16_f32 v26, v24, v24
    v_and_b32 v27, 0xffff0000, v26
    v_sub_f32 v27, v24, v27
    v_cvt_pk_bf16_f32 v27, v27, v27
    v_cndmask_b32 v26, v27, v26, s[60:61]
    v_and_b32 v58, 0xffff, v26
    v_lshlrev_b32 v25, 16, v25
    v_mul_f32 v25, s3, v25
    v_cvt_pk_bf16_f32 v26, v25, v25
    v_and_b32 v27, 0xffff0000, v26
    v_sub_f32 v27, v25, v27
    v_cvt_pk_bf16_f32 v27, v27, v27
    v_cndmask_b32 v26, v27, v26, s[60:61]
    v_and_b32 v60, 0xffff, v26
    s_add_u32 s28, s14, 2621440
    s_addc_u32 s29, s15, 0
    s_mov_b32 s30, 8192
    s_mov_b32 s31, 0x00020000
    v_lshlrev_b32 v2, 4, v1
    v_lshlrev_b32 v3, 3, v1
    s_movk_i32 s3, 0x1000
    buffer_store_dwordx4 v[32:35], v2, s[28:31], 0 offen offset:0
    buffer_store_dwordx4 v[36:39], v2, s[28:31], 0 offen offset:1024
    buffer_store_dwordx4 v[40:43], v2, s[28:31], 0 offen offset:2048
    buffer_store_dwordx4 v[44:47], v2, s[28:31], 0 offen offset:3072
    buffer_store_dwordx4 v[52:55], v2, s[28:31], s3 offen
    buffer_store_dwordx2 v[56:57], v3, s[28:31], s3 offen offset:1024
    buffer_store_dwordx2 v[58:59], v3, s[28:31], s3 offen offset:1536
    buffer_store_dwordx2 v[60:61], v3, s[28:31], s3 offen offset:2048
    buffer_store_dwordx2 v[62:63], v3, s[28:31], s3 offen offset:2560
    buffer_store_dwordx2 v[48:49], v3, s[28:31], s3 offen offset:3072
K1_END:
    s_endpgm
.globl k2_kernel
.p2align 8
.type k2_kernel,@function
k2_kernel:
    s_cmp_ge_u32 s2, 256
    s_cbranch_scc1 K2_END
    s_load_dwordx2 s[14:15], s[0:1], 64
    s_load_dwordx2 s[4:5], s[0:1], 0
    s_load_dwordx2 s[12:13], s[0:1], 48
    s_setprio 3
    v_add_u32 v0, 768, v0
    v_and_b32 v0, 1023, v0
    v_lshrrev_b32 v2, 6, v0
    v_and_b32 v1, 63, v0
    v_readfirstlane_b32 s46, v2
    s_and_b32 s3, s2, 7
    s_lshl_b32 s3, s3, 5
    s_lshr_b32 s44, s2, 3
    s_add_u32 s44, s44, s3
    v_mul_u32_u24 v12, 0x5556, v0
    v_lshrrev_b32 v12, 16, v12
    v_lshlrev_b32 v3, 2, v12
    v_and_b32 v4, 31, v12
    v_lshrrev_b32 v12, 5, v12
    v_lshl_add_u32 v12, v4, 3, v12
    s_lshl_b32 s3, s44, 10
    s_mov_b32 s38, 262144
    s_mov_b32 s39, 0x00020000
    s_cmp_ge_u32 s46, 12
    s_cselect_b32 s27, 1, 0
    s_cbranch_scc1 K2_HELP
    s_waitcnt lgkmcnt(0)
    s_add_u32 s36, s14, 2097152
    s_addc_u32 s37, s15, 0
    buffer_load_dword v127, v3, s[36:39], s3 offen
    s_barrier
    s_add_u32 s40, s14, 4194304
    s_addc_u32 s41, s15, 0
    s_mov_b32 s42, 4224000
    s_mov_b32 s43, 0x00020000
    v_mul_u32_u24 v3, 0x5556, v0
    v_lshrrev_b32 v4, 16, v3
    v_mul_u32_u24 v3, 3, v4
    v_sub_u32 v3, v0, v3
    v_lshlrev_b32 v3, 2, v3
    v_mul_u32_u24 v4, 4224, v12
    v_mov_b32 v6, 250
    v_cmp_lt_u32 s[86:87], v12, v6
    s_waitcnt vmcnt(0)
    s_nop 0
    v_cndmask_b32 v127, 0, v127, s[86:87]
    v_lshrrev_b32 v5, 16, v127
    v_sub_u32 v2, v5, v3
    v_cmp_lt_i32 s[60:61], 0, v2
    v_cmp_lt_i32 s[68:69], 12, v2
    v_cmp_lt_i32 s[76:77], 24, v2
    v_and_b32 v6, 0xffff, v127
    v_add_u32 v4, v6, v4
    v_add_lshl_u32 v5, v4, v5, 2
    v_add_lshl_u32 v4, v4, v3, 2
    v_add_u32 v5, v5, v3
    s_or_b64 exec, s[60:61], s[60:61]
    buffer_load_dword v44, v5, s[40:43], 0 offen offset:0
    buffer_load_dwordx4 v[32:35], v4, s[40:43], 0 offen offset:0
    s_or_b64 exec, s[68:69], s[68:69]
    buffer_load_dword v45, v5, s[40:43], 0 offen offset:12
    buffer_load_dwordx4 v[36:39], v4, s[40:43], 0 offen offset:48
    s_or_b64 exec, s[76:77], s[76:77]
    s_cbranch_scc0 K2_RL1
    buffer_load_dword v46, v5, s[40:43], 0 offen offset:24
    buffer_load_dwordx4 v[40:43], v4, s[40:43], 0 offen offset:96
K2_RL1:
    s_mov_b64 exec, -1
    s_mov_b32 s50, 0
    s_add_u32 s20, s14, 4096
    s_addc_u32 s21, s15, 0
    s_mov_b32 s22, 1600000
    s_mov_b32 s23, 0x00020000
    s_mov_b32 s32, s20
    s_or_b32 s33, s21, 8388608
    s_mov_b32 s34, 12500
    s_mov_b32 s35, 0x00020000
    s_mov_b32 s28, s12
    s_mov_b32 s29, s13
    s_mov_b32 s30, 1600000
    s_mov_b32 s31, 0x00020000
    s_add_u32 s40, s14, 4194304
    s_addc_u32 s41, s15, 0
    s_mov_b32 s42, 4224000
    s_mov_b32 s43, 0x00020000
    s_mov_b32 s12, 0x2d800000
    s_mov_b32 s13, 0x2d800000
    s_movk_i32 s6, 112
    s_mov_b32 s7, 53440
    s_mov_b32 s51, 0
    s_mov_b32 s55, 0
    s_mov_b32 s50, 0
    s_mov_b32 s24, 7
    s_mov_b32 s25, 6
    s_mov_b32 s58, 1.0
    s_mov_b32 s59, 1.0
    s_lshl_b32 s47, s46, 12
    s_add_u32 s47, s47, 89216
    s_mul_i32 s45, s44, 49
    s_lshr_b32 s54, s2, 3
    v_cmp_lt_i32 s[62:63], 1, v2
    v_cmp_lt_i32 s[64:65], 2, v2
    v_cmp_lt_i32 s[66:67], 3, v2
    v_cmp_lt_i32 s[70:71], 13, v2
    v_cmp_lt_i32 s[72:73], 14, v2
    v_cmp_lt_i32 s[74:75], 15, v2
    v_cmp_lt_i32 s[78:79], 25, v2
    v_cmp_lt_i32 s[80:81], 26, v2
    v_cmp_lt_i32 s[82:83], 27, v2
    v_lshrrev_b32 v8, 4, v1
    v_lshl_add_u32 v8, s46, 2, v8
    v_mul_u32_u24 v9, 448, v8
    v_lshlrev_b32 v11, 1, v1
    v_and_b32 v11, 16, v11
    v_add3_u32 v12, v9, v11, s7
    v_bfe_u32 v8, v1, 4, 1
    v_lshrrev_b32 v9, 5, v1
    v_lshl_or_b32 v8, v9, 2, v8
    v_and_b32 v9, 7, v1
    v_xor_b32 v8, v8, v9
    v_lshlrev_b32 v105, 4, v8
    v_xor_b32 v107, 32, v105
    v_mov_b32 v109, v105
    v_mov_b32 v111, v107
    v_mov_b32 v126, 0
    v_mov_b32 v15, 0
    s_mul_i32 s3, s54, 16896
    v_lshlrev_b32 v17, 7, v0
    v_add_u32 v17, s3, v17
    v_lshrrev_b32 v16, 16, v127
    v_cmp_lt_u32 vcc, 36, v16
    s_nop 1
    s_cbranch_vccz K2_PASS
    s_mov_b64 exec, vcc
    v_mov_b32 v3, 624
    ds_max_u32 v3, v16
    s_mov_b64 exec, -1
K2_PASS:
    v_mov_b32 v2, 1
    v_min_u32 v18, 48, v1
    v_mul_u32_u24 v19, 12, v18
    v_mul_u32_u24 v18, 112, v18
    v_add_u32 v18, 13472, v18
    v_lshlrev_b32 v3, 4, v1
    v_add_u32 v14, 81472, v3
    v_mov_b32 v5, 4
K2_QPOLL0:
    ds_read_b32 v8, v5
    s_waitcnt lgkmcnt(0)
    v_readfirstlane_b32 s3, v8
    s_cmp_lt_u32 s3, 4
    s_cbranch_scc1 K2_QPOLL0
    v_lshlrev_b32 v3, 3, v1
    v_add_u32 v3, 86592, v3
    ds_read_b64 v[122:123], v3 offset:1536
    ds_read_b128 v[112:115], v14 offset:3072
    ds_read_b64 v[116:117], v3 offset:2048
    ds_read_b128 v[100:103], v14 offset:2048
    ds_read_b128 v[92:95], v14
    ds_read_b128 v[96:99], v14 offset:1024
    ds_read_b64 v[80:81], v3
    ds_read_b64 v[86:87], v3 offset:512
    ds_read_b64 v[90:91], v3 offset:1024
    v_mov_b32 v83, 0
    s_mul_i32 s84, s46, 1792
    s_mul_i32 s85, s46, 2112
    s_waitcnt lgkmcnt(0)
    v_add_u32 v13, s84, v122
    v_add_u32 v120, s85, v123
    v_add_u32 v121, 528, v120
    s_lshl_b32 s3, s46, 5
    s_lshl_b32 s4, s25, 9
    s_add_u32 s3, s3, s4
    v_add_u32 v112, s3, v112
    v_add_u32 v113, s3, v113
    v_add_u32 v114, s3, v114
    v_add_u32 v100, s47, v100
    v_add_u32 v101, s47, v101
    v_add_u32 v102, s47, v102
    v_add_u32 v103, s47, v103
    s_or_b64 s[84:85], s[76:77], s[78:79]
    s_or_b64 s[84:85], s[84:85], s[80:81]
    s_or_b64 s[84:85], s[84:85], s[82:83]
    s_cselect_b32 s56, 1, 0
    s_waitcnt vmcnt(0)
    v_lshlrev_b32_sdwa v48, 2, v44 dst_sel:DWORD dst_unused:UNUSED_PAD src0_sel:DWORD src1_sel:BYTE_0
    v_lshlrev_b32_sdwa v49, 2, v44 dst_sel:DWORD dst_unused:UNUSED_PAD src0_sel:DWORD src1_sel:BYTE_1
    v_lshlrev_b32_sdwa v50, 2, v44 dst_sel:DWORD dst_unused:UNUSED_PAD src0_sel:DWORD src1_sel:BYTE_2
    v_lshlrev_b32_sdwa v51, 2, v44 dst_sel:DWORD dst_unused:UNUSED_PAD src0_sel:DWORD src1_sel:BYTE_3
    s_mov_b64 exec, s[60:61]
    ds_add_rtn_u32 v60, v48, v2 offset:16
    s_mov_b64 exec, s[62:63]
    ds_add_rtn_u32 v61, v49, v2 offset:16
    s_mov_b64 exec, s[64:65]
    ds_add_rtn_u32 v62, v50, v2 offset:16
    s_mov_b64 exec, s[66:67]
    ds_add_rtn_u32 v63, v51, v2 offset:16
    s_mov_b64 exec, -1
    v_lshlrev_b32_sdwa v52, 2, v45 dst_sel:DWORD dst_unused:UNUSED_PAD src0_sel:DWORD src1_sel:BYTE_0
    v_lshlrev_b32_sdwa v53, 2, v45 dst_sel:DWORD dst_unused:UNUSED_PAD src0_sel:DWORD src1_sel:BYTE_1
    v_lshlrev_b32_sdwa v54, 2, v45 dst_sel:DWORD dst_unused:UNUSED_PAD src0_sel:DWORD src1_sel:BYTE_2
    v_lshlrev_b32_sdwa v55, 2, v45 dst_sel:DWORD dst_unused:UNUSED_PAD src0_sel:DWORD src1_sel:BYTE_3
    s_mov_b64 exec, s[68:69]
    ds_add_rtn_u32 v64, v52, v2 offset:16
    s_mov_b64 exec, s[70:71]
    ds_add_rtn_u32 v65, v53, v2 offset:16
    s_mov_b64 exec, s[72:73]
    ds_add_rtn_u32 v66, v54, v2 offset:16
    s_mov_b64 exec, s[74:75]
    ds_add_rtn_u32 v67, v55, v2 offset:16
    s_mov_b64 exec, -1
    s_cbranch_scc0 K2_RK8
    v_lshlrev_b32_sdwa v56, 2, v46 dst_sel:DWORD dst_unused:UNUSED_PAD src0_sel:DWORD src1_sel:BYTE_0
    v_lshlrev_b32_sdwa v57, 2, v46 dst_sel:DWORD dst_unused:UNUSED_PAD src0_sel:DWORD src1_sel:BYTE_1
    v_lshlrev_b32_sdwa v58, 2, v46 dst_sel:DWORD dst_unused:UNUSED_PAD src0_sel:DWORD src1_sel:BYTE_2
    v_lshlrev_b32_sdwa v59, 2, v46 dst_sel:DWORD dst_unused:UNUSED_PAD src0_sel:DWORD src1_sel:BYTE_3
    s_mov_b64 exec, s[76:77]
    ds_add_rtn_u32 v68, v56, v2 offset:16
    s_mov_b64 exec, s[78:79]
    ds_add_rtn_u32 v69, v57, v2 offset:16
    s_mov_b64 exec, s[80:81]
    ds_add_rtn_u32 v70, v58, v2 offset:16
    s_mov_b64 exec, s[82:83]
    ds_add_rtn_u32 v71, v59, v2 offset:16
    s_mov_b64 exec, -1
K2_RK8:
    s_cmp_ge_u32 s46, 3
    s_cbranch_scc1 K2_NOWARM
    buffer_load_dword v125, v17, s[20:23], 0 offen
K2_NOWARM:
    s_waitcnt lgkmcnt(0)
    s_barrier
    ds_read2_b32 v[8:9], v19 offset0:5 offset1:6
    ds_read_b32 v20, v48 offset:12
    ds_read_b32 v21, v49 offset:12
    ds_read_b32 v22, v50 offset:12
    ds_read_b32 v23, v51 offset:12
    s_mov_b64 exec, s[68:69]
    ds_read_b32 v24, v52 offset:12
    s_mov_b64 exec, s[70:71]
    ds_read_b32 v25, v53 offset:12
    s_mov_b64 exec, s[72:73]
    ds_read_b32 v26, v54 offset:12
    s_mov_b64 exec, s[74:75]
    ds_read_b32 v27, v55 offset:12
    s_cmp_eq_u32 s56, 0
    s_cbranch_scc1 K2_PL0
    s_mov_b64 exec, s[76:77]
    ds_read_b32 v28, v56 offset:12
    s_mov_b64 exec, s[78:79]
    ds_read_b32 v29, v57 offset:12
    s_mov_b64 exec, s[80:81]
    ds_read_b32 v30, v58 offset:12
    s_mov_b64 exec, s[82:83]
    ds_read_b32 v31, v59 offset:12
K2_PL0:
    s_mov_b64 exec, -1
    s_waitcnt lgkmcnt(0)
    v_add_u32 v8, v8, v9
    v_cmp_gt_u32 vcc, v8, v18
    s_nop 1
    s_cbranch_vccnz K2_CAREFUL
    s_mov_b64 exec, s[60:61]
    v_add_lshl_u32 v48, v60, v20, 2
    ds_write_b32 v48, v32
    s_mov_b64 exec, s[62:63]
    v_add_lshl_u32 v49, v61, v21, 2
    ds_write_b32 v49, v33
    s_mov_b64 exec, s[64:65]
    v_add_lshl_u32 v50, v62, v22, 2
    ds_write_b32 v50, v34
    s_mov_b64 exec, s[66:67]
    v_add_lshl_u32 v51, v63, v23, 2
    ds_write_b32 v51, v35
    s_mov_b64 exec, s[68:69]
    v_add_lshl_u32 v52, v64, v24, 2
    ds_write_b32 v52, v36
    s_mov_b64 exec, s[70:71]
    v_add_lshl_u32 v53, v65, v25, 2
    ds_write_b32 v53, v37
    s_mov_b64 exec, s[72:73]
    v_add_lshl_u32 v54, v66, v26, 2
    ds_write_b32 v54, v38
    s_mov_b64 exec, s[74:75]
    v_add_lshl_u32 v55, v67, v27, 2
    ds_write_b32 v55, v39
    s_cbranch_scc1 K2_PL4
    s_mov_b64 exec, s[76:77]
    v_add_lshl_u32 v56, v68, v28, 2
    ds_write_b32 v56, v40
    s_mov_b64 exec, s[78:79]
    v_add_lshl_u32 v57, v69, v29, 2
    ds_write_b32 v57, v41
    s_mov_b64 exec, s[80:81]
    v_add_lshl_u32 v58, v70, v30, 2
    ds_write_b32 v58, v42
    s_mov_b64 exec, s[82:83]
    v_add_lshl_u32 v59, v71, v31, 2
    ds_write_b32 v59, v43
K2_PL4:
    s_mov_b64 exec, -1
    s_waitcnt lgkmcnt(0)
    s_barrier
    s_cmp_lg_u32 s51, 0
    s_cbranch_scc1 K2_SLOWHEAD
    ds_read_u16 v104, v12 offset:0
    ds_read_u16 v106, v12 offset:4
    ds_read_u16 v108, v12 offset:8
    ds_read_u16 v110, v12 offset:12
    s_waitcnt lgkmcnt(0)
    s_mov_b32 m0, s47
    s_nop 0
    buffer_load_dwordx4 v[104:105], s[32:35], 0 idxen offen lds
    s_add_u32 m0, s47, 1024
    s_nop 0
    buffer_load_dwordx4 v[106:107], s[32:35], 0 idxen offen lds
    s_add_u32 m0, s47, 2048
    s_nop 0
    buffer_load_dwordx4 v[108:109], s[32:35], 0 idxen offen lds
    s_add_u32 m0, s47, 3072
    s_nop 0
    buffer_load_dwordx4 v[110:111], s[32:35], 0 idxen offen lds
    ds_read_u16 v104, v12 offset:32
    ds_read_u16 v106, v12 offset:36
    ds_read_u16 v108, v12 offset:40
    ds_read_u16 v110, v12 offset:44
    v_mov_b32 v2, 632
    ds_read_b64 v[4:5], v2
    ds_read_u16 v82, v13
    ds_read_b32 v84, v120 offset:27040
    ds_read_b32 v85, v121 offset:27040
    ds_read_b32 v88, v120 offset:27296
    ds_read_b32 v89, v121 offset:27296
    s_waitcnt lgkmcnt(5)
    v_readfirstlane_b32 s26, v4
    v_readfirstlane_b32 s52, v5
    s_lshl_b32 s3, s25, 2
    s_add_u32 s3, s3, s46
    s_sub_i32 s48, s26, s3
    s_add_i32 s48, s48, 15
    s_max_i32 s48, s48, 0
    s_lshr_b32 s48, s48, 4
    s_sub_i32 s3, s26, s46
    s_add_i32 s3, s3, 15
    s_max_i32 s3, s3, 0
    s_lshr_b32 s3, s3, 2
    s_min_u32 s3, s3, s25
    s_mul_i32 s3, s3, s27
    s_add_u32 s48, s48, s3
    s_mov_b32 s49, 100
    s_setprio 3
    s_waitcnt vmcnt(0)
    ds_read_b128 v[64:67], v100
    ds_read_b128 v[68:71], v101
    ds_read_b128 v[72:75], v102
    ds_read_b128 v[76:79], v103
    s_waitcnt lgkmcnt(0)
    s_mov_b32 m0, s47
    s_nop 0
    buffer_load_dwordx4 v[104:105], s[32:35], 0 idxen offen lds
    s_add_u32 m0, s47, 1024
    s_nop 0
    buffer_load_dwordx4 v[106:107], s[32:35], 0 idxen offen lds
    s_add_u32 m0, s47, 2048
    s_nop 0
    buffer_load_dwordx4 v[108:109], s[32:35], 0 idxen offen lds
    s_add_u32 m0, s47, 3072
    s_nop 0
    buffer_load_dwordx4 v[110:111], s[32:35], 0 idxen offen lds
    v_mfma_f32_32x32x16_bf16 v[16:31], v[80:83], v[84:87], 0
    v_mfma_f32_32x32x16_bf16 v[16:31], v[64:67], v[92:95], v[16:31]
    v_mfma_f32_32x32x16_bf16 v[16:31], v[68:71], v[96:99], v[16:31]
    s_nop 7
    s_nop 3
    ds_read_u16 v104, v12 offset:64
    ds_read_u16 v106, v12 offset:68
    ds_read_u16 v108, v12 offset:72
    ds_read_u16 v110, v12 offset:76
    v_mfma_f32_32x32x16_bf16 v[32:47], v[80:83], v[88:91], 0
    v_exp_f32 v48, v16
    v_exp_f32 v49, v17
    v_exp_f32 v50, v18
    v_exp_f32 v51, v19
    v_mfma_f32_32x32x16_bf16 v[32:47], v[72:75], v[92:95], v[32:47]
    v_exp_f32 v52, v20
    v_exp_f32 v53, v21
    v_exp_f32 v54, v22
    v_exp_f32 v55, v23
    v_mfma_f32_32x32x16_bf16 v[32:47], v[76:79], v[96:99], v[32:47]
    v_exp_f32 v56, v24
    v_exp_f32 v57, v25
    v_exp_f32 v58, v26
    v_exp_f32 v59, v27
    v_exp_f32 v60, v28
    v_exp_f32 v61, v29
    v_exp_f32 v62, v30
    v_exp_f32 v63, v31
    s_waitcnt vmcnt(0) lgkmcnt(0)
    ds_read_b128 v[64:67], v100
    ds_read_b128 v[68:71], v101
    ds_read_b128 v[72:75], v102
    ds_read_b128 v[76:79], v103
    ds_read_u16 v82, v13 offset:32
    v_pk_add_f32 v[6:7], v[48:49], s[58:59]
    v_pk_fma_f32 v[2:3], v[16:17], v[50:51], v[16:17]
    v_pk_fma_f32 v[4:5], v[6:7], v[50:51], v[6:7]
    v_pk_fma_f32 v[2:3], v[18:19], v[6:7], v[2:3]
    v_pk_fma_f32 v[2:3], v[2:3], v[52:53], v[2:3]
    v_pk_fma_f32 v[6:7], v[4:5], v[52:53], v[4:5]
    v_pk_fma_f32 v[2:3], v[20:21], v[4:5], v[2:3]
    s_waitcnt lgkmcnt(1)
    s_mov_b32 m0, s47
    s_nop 0
    buffer_load_dwordx4 v[104:105], s[32:35], 0 idxen offen lds
    s_add_u32 m0, s47, 1024
    s_nop 0
    buffer_load_dwordx4 v[106:107], s[32:35], 0 idxen offen lds
    s_add_u32 m0, s47, 2048
    s_nop 0
    buffer_load_dwordx4 v[108:109], s[32:35], 0 idxen offen lds
    s_add_u32 m0, s47, 3072
    s_nop 0
    buffer_load_dwordx4 v[110:111], s[32:35], 0 idxen offen lds
    v_pk_fma_f32 v[2:3], v[2:3], v[54:55], v[2:3]
    v_pk_fma_f32 v[4:5], v[6:7], v[54:55], v[6:7]
    v_pk_fma_f32 v[2:3], v[22:23], v[6:7], v[2:3]
    v_pk_fma_f32 v[2:3], v[2:3], v[56:57], v[2:3]
    v_pk_fma_f32 v[6:7], v[4:5], v[56:57], v[4:5]
    v_pk_fma_f32 v[2:3], v[24:25], v[4:5], v[2:3]
    v_pk_fma_f32 v[2:3], v[2:3], v[58:59], v[2:3]
    v_pk_fma_f32 v[4:5], v[6:7], v[58:59], v[6:7]
    v_pk_fma_f32 v[2:3], v[26:27], v[6:7], v[2:3]
    v_pk_fma_f32 v[2:3], v[2:3], v[60:61], v[2:3]
    v_pk_fma_f32 v[6:7], v[4:5], v[60:61], v[4:5]
    v_pk_fma_f32 v[2:3], v[28:29], v[4:5], v[2:3]
    v_pk_fma_f32 v[2:3], v[2:3], v[62:63], v[2:3]
    v_pk_fma_f32 v[4:5], v[6:7], v[62:63], v[6:7]
    v_pk_fma_f32 v[2:3], v[30:31], v[6:7], v[2:3]
    s_waitcnt lgkmcnt(0)
    v_mfma_f32_32x32x16_bf16 v[16:31], v[80:83], v[84:87], 0
    v_exp_f32 v48, v32
    v_exp_f32 v49, v33
    v_exp_f32 v50, v34
    v_exp_f32 v51, v35
    v_mfma_f32_32x32x16_bf16 v[16:31], v[64:67], v[92:95], v[16:31]
    v_exp_f32 v52, v36
    v_exp_f32 v53, v37
    v_exp_f32 v54, v38
    v_exp_f32 v55, v39
    v_mfma_f32_32x32x16_bf16 v[16:31], v[68:71], v[96:99], v[16:31]
    v_exp_f32 v56, v40
    v_exp_f32 v57, v41
    v_exp_f32 v58, v42
    v_exp_f32 v59, v43
    v_exp_f32 v60, v44
    v_exp_f32 v61, v45
    v_exp_f32 v62, v46
    v_exp_f32 v63, v47
    v_pk_add_f32 v[6:7], v[48:49], s[58:59]
    v_pk_fma_f32 v[8:9], v[32:33], v[50:51], v[32:33]
    v_pk_fma_f32 v[10:11], v[6:7], v[50:51], v[6:7]
    v_pk_fma_f32 v[8:9], v[34:35], v[6:7], v[8:9]
    v_pk_fma_f32 v[8:9], v[8:9], v[52:53], v[8:9]
    v_pk_fma_f32 v[6:7], v[10:11], v[52:53], v[10:11]
    v_pk_fma_f32 v[8:9], v[36:37], v[10:11], v[8:9]
    v_pk_fma_f32 v[8:9], v[8:9], v[54:55], v[8:9]
    v_pk_fma_f32 v[10:11], v[6:7], v[54:55], v[6:7]
    v_pk_fma_f32 v[8:9], v[38:39], v[6:7], v[8:9]
    v_pk_fma_f32 v[8:9], v[8:9], v[56:57], v[8:9]
    v_pk_fma_f32 v[6:7], v[10:11], v[56:57], v[10:11]
    v_pk_fma_f32 v[8:9], v[40:41], v[10:11], v[8:9]
    v_pk_fma_f32 v[8:9], v[8:9], v[58:59], v[8:9]
    v_pk_fma_f32 v[10:11], v[6:7], v[58:59], v[6:7]
    v_pk_fma_f32 v[8:9], v[42:43], v[6:7], v[8:9]
    v_pk_fma_f32 v[8:9], v[8:9], v[60:61], v[8:9]
    v_pk_fma_f32 v[6:7], v[10:11], v[60:61], v[10:11]
    v_pk_fma_f32 v[8:9], v[44:45], v[10:11], v[8:9]
    v_pk_fma_f32 v[8:9], v[8:9], v[62:63], v[8:9]
    v_pk_fma_f32 v[10:11], v[6:7], v[62:63], v[6:7]
    v_pk_fma_f32 v[8:9], v[46:47], v[6:7], v[8:9]
    ds_read_u16 v104, v12 offset:96
    ds_read_u16 v106, v12 offset:100
    ds_read_u16 v108, v12 offset:104
    ds_read_u16 v110, v12 offset:108
    v_mfma_f32_32x32x16_bf16 v[32:47], v[80:83], v[88:91], 0
    v_exp_f32 v48, v16
    v_exp_f32 v49, v17
    v_exp_f32 v50, v18
    v_exp_f32 v51, v19
    v_mfma_f32_32x32x16_bf16 v[32:47], v[72:75], v[92:95], v[32:47]
    v_exp_f32 v52, v20
    v_exp_f32 v53, v21
    v_exp_f32 v54, v22
    v_exp_f32 v55, v23
    v_mfma_f32_32x32x16_bf16 v[32:47], v[76:79], v[96:99], v[32:47]
    v_exp_f32 v56, v24
    v_exp_f32 v57, v25
    v_exp_f32 v58, v26
    v_exp_f32 v59, v27
    v_exp_f32 v60, v28
    v_exp_f32 v61, v29
    v_exp_f32 v62, v30
    v_exp_f32 v63, v31
    s_waitcnt vmcnt(0) lgkmcnt(0)
    ds_read_b128 v[64:67], v100
    ds_read_b128 v[68:71], v101
    ds_read_b128 v[72:75], v102
    ds_read_b128 v[76:79], v103
    ds_read_u16 v82, v13 offset:64
    v_pk_fma_f32 v[2:3], v[2:3], v[48:49], v[2:3]
    v_pk_fma_f32 v[6:7], v[4:5], v[48:49], v[4:5]
    v_pk_fma_f32 v[2:3], v[16:17], v[4:5], v[2:3]
    v_pk_fma_f32 v[2:3], v[2:3], v[50:51], v[2:3]
    v_pk_fma_f32 v[4:5], v[6:7], v[50:51], v[6:7]
    v_pk_fma_f32 v[2:3], v[18:19], v[6:7], v[2:3]
    v_pk_fma_f32 v[2:3], v[2:3], v[52:53], v[2:3]
    v_pk_fma_f32 v[6:7], v[4:5], v[52:53], v[4:5]
    v_pk_fma_f32 v[2:3], v[20:21], v[4:5], v[2:3]
    s_waitcnt lgkmcnt(1)
    s_mov_b32 m0, s47
    s_nop 0
    buffer_load_dwordx4 v[104:105], s[32:35], 0 idxen offen lds
    s_add_u32 m0, s47, 1024
    s_nop 0
    buffer_load_dwordx4 v[106:107], s[32:35], 0 idxen offen lds
    s_add_u32 m0, s47, 2048
    s_nop 0
    buffer_load_dwordx4 v[108:109], s[32:35], 0 idxen offen lds
    s_add_u32 m0, s47, 3072
    s_nop 0
    buffer_load_dwordx4 v[110:111], s[32:35], 0 idxen offen lds
    v_pk_fma_f32 v[2:3], v[2:3], v[54:55], v[2:3]
    v_pk_fma_f32 v[4:5], v[6:7], v[54:55], v[6:7]
    v_pk_fma_f32 v[2:3], v[22:23], v[6:7], v[2:3]
    v_pk_fma_f32 v[2:3], v[2:3], v[56:57], v[2:3]
    v_pk_fma_f32 v[6:7], v[4:5], v[56:57], v[4:5]
    v_pk_fma_f32 v[2:3], v[24:25], v[4:5], v[2:3]
    v_pk_fma_f32 v[2:3], v[2:3], v[58:59], v[2:3]
    v_pk_fma_f32 v[4:5], v[6:7], v[58:59], v[6:7]
    v_pk_fma_f32 v[2:3], v[26:27], v[6:7], v[2:3]
    v_pk_fma_f32 v[2:3], v[2:3], v[60:61], v[2:3]
    v_pk_fma_f32 v[6:7], v[4:5], v[60:61], v[4:5]
    v_pk_fma_f32 v[2:3], v[28:29], v[4:5], v[2:3]
    v_pk_fma_f32 v[2:3], v[2:3], v[62:63], v[2:3]
    v_pk_fma_f32 v[4:5], v[6:7], v[62:63], v[6:7]
    v_pk_fma_f32 v[2:3], v[30:31], v[6:7], v[2:3]
    s_waitcnt lgkmcnt(0)
    v_mfma_f32_32x32x16_bf16 v[16:31], v[80:83], v[84:87], 0
    v_exp_f32 v48, v32
    v_exp_f32 v49, v33
    v_exp_f32 v50, v34
    v_exp_f32 v51, v35
    v_mfma_f32_32x32x16_bf16 v[16:31], v[64:67], v[92:95], v[16:31]
    v_exp_f32 v52, v36
    v_exp_f32 v53, v37
    v_exp_f32 v54, v38
    v_exp_f32 v55, v39
    v_mfma_f32_32x32x16_bf16 v[16:31], v[68:71], v[96:99], v[16:31]
    v_exp_f32 v56, v40
    v_exp_f32 v57, v41
    v_exp_f32 v58, v42
    v_exp_f32 v59, v43
    v_exp_f32 v60, v44
    v_exp_f32 v61, v45
    v_exp_f32 v62, v46
    v_exp_f32 v63, v47
    v_pk_fma_f32 v[8:9], v[8:9], v[48:49], v[8:9]
    v_pk_fma_f32 v[6:7], v[10:11], v[48:49], v[10:11]
    v_pk_fma_f32 v[8:9], v[32:33], v[10:11], v[8:9]
    v_pk_fma_f32 v[8:9], v[8:9], v[50:51], v[8:9]
    v_pk_fma_f32 v[10:11], v[6:7], v[50:51], v[6:7]
    v_pk_fma_f32 v[8:9], v[34:35], v[6:7], v[8:9]
    v_pk_fma_f32 v[8:9], v[8:9], v[52:53], v[8:9]
    v_pk_fma_f32 v[6:7], v[10:11], v[52:53], v[10:11]
    v_pk_fma_f32 v[8:9], v[36:37], v[10:11], v[8:9]
    v_pk_fma_f32 v[8:9], v[8:9], v[54:55], v[8:9]
    v_pk_fma_f32 v[10:11], v[6:7], v[54:55], v[6:7]
    v_pk_fma_f32 v[8:9], v[38:39], v[6:7], v[8:9]
    v_pk_fma_f32 v[8:9], v[8:9], v[56:57], v[8:9]
    v_pk_fma_f32 v[6:7], v[10:11], v[56:57], v[10:11]
    v_pk_fma_f32 v[8:9], v[40:41], v[10:11], v[8:9]
    v_pk_fma_f32 v[8:9], v[8:9], v[58:59], v[8:9]
    v_pk_fma_f32 v[10:11], v[6:7], v[58:59], v[6:7]
    v_pk_fma_f32 v[8:9], v[42:43], v[6:7], v[8:9]
    v_pk_fma_f32 v[8:9], v[8:9], v[60:61], v[8:9]
    v_pk_fma_f32 v[6:7], v[10:11], v[60:61], v[10:11]
    v_pk_fma_f32 v[8:9], v[44:45], v[10:11], v[8:9]
    v_pk_fma_f32 v[8:9], v[8:9], v[62:63], v[8:9]
    v_pk_fma_f32 v[10:11], v[6:7], v[62:63], v[6:7]
    v_pk_fma_f32 v[8:9], v[46:47], v[6:7], v[8:9]
    v_pk_mul_f32 v[2:3], v[2:3], s[12:13]
    v_pk_mul_f32 v[4:5], v[4:5], s[12:13]
    v_pk_mul_f32 v[8:9], v[8:9], s[12:13]
    v_pk_mul_f32 v[10:11], v[10:11], s[12:13]
    s_setprio 2
    ds_read_u16 v104, v12 offset:128
    ds_read_u16 v106, v12 offset:132
    ds_read_u16 v108, v12 offset:136
    ds_read_u16 v110, v12 offset:140
    v_mfma_f32_32x32x16_bf16 v[32:47], v[80:83], v[88:91], 0
    v_exp_f32 v48, v16
    v_exp_f32 v49, v17
    v_exp_f32 v50, v18
    v_exp_f32 v51, v19
    v_mfma_f32_32x32x16_bf16 v[32:47], v[72:75], v[92:95], v[32:47]
    v_exp_f32 v52, v20
    v_exp_f32 v53, v21
    v_exp_f32 v54, v22
    v_exp_f32 v55, v23
    v_mfma_f32_32x32x16_bf16 v[32:47], v[76:79], v[96:99], v[32:47]
    v_exp_f32 v56, v24
    v_exp_f32 v57, v25
    v_exp_f32 v58, v26
    v_exp_f32 v59, v27
    v_exp_f32 v60, v28
    v_exp_f32 v61, v29
    v_exp_f32 v62, v30
    v_exp_f32 v63, v31
    s_waitcnt vmcnt(0) lgkmcnt(0)
    ds_read_b128 v[64:67], v100
    ds_read_b128 v[68:71], v101
    ds_read_b128 v[72:75], v102
    ds_read_b128 v[76:79], v103
    ds_read_u16 v82, v13 offset:96
    v_pk_fma_f32 v[2:3], v[2:3], v[48:49], v[2:3]
    v_pk_fma_f32 v[6:7], v[4:5], v[48:49], v[4:5]
    v_pk_fma_f32 v[2:3], v[16:17], v[4:5], v[2:3]
    v_pk_fma_f32 v[2:3], v[2:3], v[50:51], v[2:3]
    v_pk_fma_f32 v[4:5], v[6:7], v[50:51], v[6:7]
    v_pk_fma_f32 v[2:3], v[18:19], v[6:7], v[2:3]
    v_pk_fma_f32 v[2:3], v[2:3], v[52:53], v[2:3]
    v_pk_fma_f32 v[6:7], v[4:5], v[52:53], v[4:5]
    v_pk_fma_f32 v[2:3], v[20:21], v[4:5], v[2:3]
    s_waitcnt lgkmcnt(1)
    s_mov_b32 m0, s47
    s_nop 0
    buffer_load_dwordx4 v[104:105], s[32:35], 0 idxen offen lds
    s_add_u32 m0, s47, 1024
    s_nop 0
    buffer_load_dwordx4 v[106:107], s[32:35], 0 idxen offen lds
    s_add_u32 m0, s47, 2048
    s_nop 0
    buffer_load_dwordx4 v[108:109], s[32:35], 0 idxen offen lds
    s_add_u32 m0, s47, 3072
    s_nop 0
    buffer_load_dwordx4 v[110:111], s[32:35], 0 idxen offen lds
    v_pk_fma_f32 v[2:3], v[2:3], v[54:55], v[2:3]
    v_pk_fma_f32 v[4:5], v[6:7], v[54:55], v[6:7]
    v_pk_fma_f32 v[2:3], v[22:23], v[6:7], v[2:3]
    v_pk_fma_f32 v[2:3], v[2:3], v[56:57], v[2:3]
    v_pk_fma_f32 v[6:7], v[4:5], v[56:57], v[4:5]
    v_pk_fma_f32 v[2:3], v[24:25], v[4:5], v[2:3]
    v_pk_fma_f32 v[2:3], v[2:3], v[58:59], v[2:3]
    v_pk_fma_f32 v[4:5], v[6:7], v[58:59], v[6:7]
    v_pk_fma_f32 v[2:3], v[26:27], v[6:7], v[2:3]
    v_pk_fma_f32 v[2:3], v[2:3], v[60:61], v[2:3]
    v_pk_fma_f32 v[6:7], v[4:5], v[60:61], v[4:5]
    v_pk_fma_f32 v[2:3], v[28:29], v[4:5], v[2:3]
    v_pk_fma_f32 v[2:3], v[2:3], v[62:63], v[2:3]
    v_pk_fma_f32 v[4:5], v[6:7], v[62:63], v[6:7]
    v_pk_fma_f32 v[2:3], v[30:31], v[6:7], v[2:3]
    s_waitcnt lgkmcnt(0)
    v_mfma_f32_32x32x16_bf16 v[16:31], v[80:83], v[84:87], 0
    v_exp_f32 v48, v32
    v_exp_f32 v49, v33
    v_exp_f32 v50, v34
    v_exp_f32 v51, v35
    v_mfma_f32_32x32x16_bf16 v[16:31], v[64:67], v[92:95], v[16:31]
    v_exp_f32 v52, v36
    v_exp_f32 v53, v37
    v_exp_f32 v54, v38
    v_exp_f32 v55, v39
    v_mfma_f32_32x32x16_bf16 v[16:31], v[68:71], v[96:99], v[16:31]
    v_exp_f32 v56, v40
    v_exp_f32 v57, v41
    v_exp_f32 v58, v42
    v_exp_f32 v59, v43
    v_exp_f32 v60, v44
    v_exp_f32 v61, v45
    v_exp_f32 v62, v46
    v_exp_f32 v63, v47
    v_pk_fma_f32 v[8:9], v[8:9], v[48:49], v[8:9]
    v_pk_fma_f32 v[6:7], v[10:11], v[48:49], v[10:11]
    v_pk_fma_f32 v[8:9], v[32:33], v[10:11], v[8:9]
    v_pk_fma_f32 v[8:9], v[8:9], v[50:51], v[8:9]
    v_pk_fma_f32 v[10:11], v[6:7], v[50:51], v[6:7]
    v_pk_fma_f32 v[8:9], v[34:35], v[6:7], v[8:9]
    v_pk_fma_f32 v[8:9], v[8:9], v[52:53], v[8:9]
    v_pk_fma_f32 v[6:7], v[10:11], v[52:53], v[10:11]
    v_pk_fma_f32 v[8:9], v[36:37], v[10:11], v[8:9]
    v_pk_fma_f32 v[8:9], v[8:9], v[54:55], v[8:9]
    v_pk_fma_f32 v[10:11], v[6:7], v[54:55], v[6:7]
    v_pk_fma_f32 v[8:9], v[38:39], v[6:7], v[8:9]
    v_pk_fma_f32 v[8:9], v[8:9], v[56:57], v[8:9]
    v_pk_fma_f32 v[6:7], v[10:11], v[56:57], v[10:11]
    v_pk_fma_f32 v[8:9], v[40:41], v[10:11], v[8:9]
    v_pk_fma_f32 v[8:9], v[8:9], v[58:59], v[8:9]
    v_pk_fma_f32 v[10:11], v[6:7], v[58:59], v[6:7]
    v_pk_fma_f32 v[8:9], v[42:43], v[6:7], v[8:9]
    v_pk_fma_f32 v[8:9], v[8:9], v[60:61], v[8:9]
    v_pk_fma_f32 v[6:7], v[10:11], v[60:61], v[10:11]
    v_pk_fma_f32 v[8:9], v[44:45], v[10:11], v[8:9]
    v_pk_fma_f32 v[8:9], v[8:9], v[62:63], v[8:9]
    v_pk_fma_f32 v[10:11], v[6:7], v[62:63], v[6:7]
    v_pk_fma_f32 v[8:9], v[46:47], v[6:7], v[8:9]
    ds_read_u16 v104, v12 offset:160
    ds_read_u16 v106, v12 offset:164
    ds_read_u16 v108, v12 offset:168
    ds_read_u16 v110, v12 offset:172
    v_mfma_f32_32x32x16_bf16 v[32:47], v[80:83], v[88:91], 0
    v_exp_f32 v48, v16
    v_exp_f32 v49, v17
    v_exp_f32 v50, v18
    v_exp_f32 v51, v19
    v_mfma_f32_32x32x16_bf16 v[32:47], v[72:75], v[92:95], v[32:47]
    v_exp_f32 v52, v20
    v_exp_f32 v53, v21
    v_exp_f32 v54, v22
    v_exp_f32 v55, v23
    v_mfma_f32_32x32x16_bf16 v[32:47], v[76:79], v[96:99], v[32:47]
    v_exp_f32 v56, v24
    v_exp_f32 v57, v25
    v_exp_f32 v58, v26
    v_exp_f32 v59, v27
    v_exp_f32 v60, v28
    v_exp_f32 v61, v29
    v_exp_f32 v62, v30
    v_exp_f32 v63, v31
    s_waitcnt vmcnt(0) lgkmcnt(0)
    ds_read_b128 v[64:67], v100
    ds_read_b128 v[68:71], v101
    ds_read_b128 v[72:75], v102
    ds_read_b128 v[76:79], v103
    ds_read_u16 v82, v13 offset:128
    v_pk_fma_f32 v[2:3], v[2:3], v[48:49], v[2:3]
    v_pk_fma_f32 v[6:7], v[4:5], v[48:49], v[4:5]
    v_pk_fma_f32 v[2:3], v[16:17], v[4:5], v[2:3]
    v_pk_fma_f32 v[2:3], v[2:3], v[50:51], v[2:3]
    v_pk_fma_f32 v[4:5], v[6:7], v[50:51], v[6:7]
    v_pk_fma_f32 v[2:3], v[18:19], v[6:7], v[2:3]
    v_pk_fma_f32 v[2:3], v[2:3], v[52:53], v[2:3]
    v_pk_fma_f32 v[6:7], v[4:5], v[52:53], v[4:5]
    v_pk_fma_f32 v[2:3], v[20:21], v[4:5], v[2:3]
    s_waitcnt lgkmcnt(1)
    s_mov_b32 m0, s47
    s_nop 0
    buffer_load_dwordx4 v[104:105], s[32:35], 0 idxen offen lds
    s_add_u32 m0, s47, 1024
    s_nop 0
    buffer_load_dwordx4 v[106:107], s[32:35], 0 idxen offen lds
    s_add_u32 m0, s47, 2048
    s_nop 0
    buffer_load_dwordx4 v[108:109], s[32:35], 0 idxen offen lds
    s_add_u32 m0, s47, 3072
    s_nop 0
    buffer_load_dwordx4 v[110:111], s[32:35], 0 idxen offen lds
    v_pk_fma_f32 v[2:3], v[2:3], v[54:55], v[2:3]
    v_pk_fma_f32 v[4:5], v[6:7], v[54:55], v[6:7]
    v_pk_fma_f32 v[2:3], v[22:23], v[6:7], v[2:3]
    v_pk_fma_f32 v[2:3], v[2:3], v[56:57], v[2:3]
    v_pk_fma_f32 v[6:7], v[4:5], v[56:57], v[4:5]
    v_pk_fma_f32 v[2:3], v[24:25], v[4:5], v[2:3]
    v_pk_fma_f32 v[2:3], v[2:3], v[58:59], v[2:3]
    v_pk_fma_f32 v[4:5], v[6:7], v[58:59], v[6:7]
    v_pk_fma_f32 v[2:3], v[26:27], v[6:7], v[2:3]
    v_pk_fma_f32 v[2:3], v[2:3], v[60:61], v[2:3]
    v_pk_fma_f32 v[6:7], v[4:5], v[60:61], v[4:5]
    v_pk_fma_f32 v[2:3], v[28:29], v[4:5], v[2:3]
    v_pk_fma_f32 v[2:3], v[2:3], v[62:63], v[2:3]
    v_pk_fma_f32 v[4:5], v[6:7], v[62:63], v[6:7]
    v_pk_fma_f32 v[2:3], v[30:31], v[6:7], v[2:3]
    s_waitcnt lgkmcnt(0)
    v_mfma_f32_32x32x16_bf16 v[16:31], v[80:83], v[84:87], 0
    v_exp_f32 v48, v32
    v_exp_f32 v49, v33
    v_exp_f32 v50, v34
    v_exp_f32 v51, v35
    v_mfma_f32_32x32x16_bf16 v[16:31], v[64:67], v[92:95], v[16:31]
    v_exp_f32 v52, v36
    v_exp_f32 v53, v37
    v_exp_f32 v54, v38
    v_exp_f32 v55, v39
    v_mfma_f32_32x32x16_bf16 v[16:31], v[68:71], v[96:99], v[16:31]
    v_exp_f32 v56, v40
    v_exp_f32 v57, v41
    v_exp_f32 v58, v42
    v_exp_f32 v59, v43
    v_exp_f32 v60, v44
    v_exp_f32 v61, v45
    v_exp_f32 v62, v46
    v_exp_f32 v63, v47
    v_pk_fma_f32 v[8:9], v[8:9], v[48:49], v[8:9]
    v_pk_fma_f32 v[6:7], v[10:11], v[48:49], v[10:11]
    v_pk_fma_f32 v[8:9], v[32:33], v[10:11], v[8:9]
    v_pk_fma_f32 v[8:9], v[8:9], v[50:51], v[8:9]
    v_pk_fma_f32 v[10:11], v[6:7], v[50:51], v[6:7]
    v_pk_fma_f32 v[8:9], v[34:35], v[6:7], v[8:9]
    v_pk_fma_f32 v[8:9], v[8:9], v[52:53], v[8:9]
    v_pk_fma_f32 v[6:7], v[10:11], v[52:53], v[10:11]
    v_pk_fma_f32 v[8:9], v[36:37], v[10:11], v[8:9]
    v_pk_fma_f32 v[8:9], v[8:9], v[54:55], v[8:9]
    v_pk_fma_f32 v[10:11], v[6:7], v[54:55], v[6:7]
    v_pk_fma_f32 v[8:9], v[38:39], v[6:7], v[8:9]
    v_pk_fma_f32 v[8:9], v[8:9], v[56:57], v[8:9]
    v_pk_fma_f32 v[6:7], v[10:11], v[56:57], v[10:11]
    v_pk_fma_f32 v[8:9], v[40:41], v[10:11], v[8:9]
    v_pk_fma_f32 v[8:9], v[8:9], v[58:59], v[8:9]
    v_pk_fma_f32 v[10:11], v[6:7], v[58:59], v[6:7]
    v_pk_fma_f32 v[8:9], v[42:43], v[6:7], v[8:9]
    v_pk_fma_f32 v[8:9], v[8:9], v[60:61], v[8:9]
    v_pk_fma_f32 v[6:7], v[10:11], v[60:61], v[10:11]
    v_pk_fma_f32 v[8:9], v[44:45], v[10:11], v[8:9]
    v_pk_fma_f32 v[8:9], v[8:9], v[62:63], v[8:9]
    v_pk_fma_f32 v[10:11], v[6:7], v[62:63], v[6:7]
    v_pk_fma_f32 v[8:9], v[46:47], v[6:7], v[8:9]
    v_pk_mul_f32 v[2:3], v[2:3], s[12:13]
    v_pk_mul_f32 v[4:5], v[4:5], s[12:13]
    v_pk_mul_f32 v[8:9], v[8:9], s[12:13]
    v_pk_mul_f32 v[10:11], v[10:11], s[12:13]
    s_setprio 1
    ds_read_u16 v104, v12 offset:192
    ds_read_u16 v106, v12 offset:196
    ds_read_u16 v108, v12 offset:200
    ds_read_u16 v110, v12 offset:204
    ds_read_b32 v124, v112
    v_mov_b32 v125, 8
    ds_read_b32 v122, v125
    v_mfma_f32_32x32x16_bf16 v[32:47], v[80:83], v[88:91], 0
    v_exp_f32 v48, v16
    v_exp_f32 v49, v17
    v_exp_f32 v50, v18
    v_exp_f32 v51, v19
    v_mfma_f32_32x32x16_bf16 v[32:47], v[72:75], v[92:95], v[32:47]
    v_exp_f32 v52, v20
    v_exp_f32 v53, v21
    v_exp_f32 v54, v22
    v_exp_f32 v55, v23
    v_mfma_f32_32x32x16_bf16 v[32:47], v[76:79], v[96:99], v[32:47]
    v_exp_f32 v56, v24
    v_exp_f32 v57, v25
    v_exp_f32 v58, v26
    v_exp_f32 v59, v27
    v_exp_f32 v60, v28
    v_exp_f32 v61, v29
    v_exp_f32 v62, v30
    v_exp_f32 v63, v31
    s_waitcnt vmcnt(0) lgkmcnt(0)
    ds_read_b128 v[64:67], v100
    ds_read_b128 v[68:71], v101
    ds_read_b128 v[72:75], v102
    ds_read_b128 v[76:79], v103
    v_readfirstlane_b32 s3, v122
    s_cmp_lt_u32 s3, 4
    s_cbranch_scc1 K2_NOTINIT
K2_INITOK:
    v_add_u32 v124, v124, v116
    ds_read_u16 v82, v13 offset:160
    v_pk_fma_f32 v[2:3], v[2:3], v[48:49], v[2:3]
    v_pk_fma_f32 v[6:7], v[4:5], v[48:49], v[4:5]
    v_pk_fma_f32 v[2:3], v[16:17], v[4:5], v[2:3]
    v_pk_fma_f32 v[2:3], v[2:3], v[50:51], v[2:3]
    v_pk_fma_f32 v[4:5], v[6:7], v[50:51], v[6:7]
    v_pk_fma_f32 v[2:3], v[18:19], v[6:7], v[2:3]
    v_pk_fma_f32 v[2:3], v[2:3], v[52:53], v[2:3]
    v_pk_fma_f32 v[6:7], v[4:5], v[52:53], v[4:5]
    v_pk_fma_f32 v[2:3], v[20:21], v[4:5], v[2:3]
    s_waitcnt lgkmcnt(1)
    s_mov_b32 m0, s47
    s_nop 0
    buffer_load_dwordx4 v[104:105], s[32:35], 0 idxen offen lds
    s_add_u32 m0, s47, 1024
    s_nop 0
    buffer_load_dwordx4 v[106:107], s[32:35], 0 idxen offen lds
    s_add_u32 m0, s47, 2048
    s_nop 0
    buffer_load_dwordx4 v[108:109], s[32:35], 0 idxen offen lds
    s_add_u32 m0, s47, 3072
    s_nop 0
    buffer_load_dwordx4 v[110:111], s[32:35], 0 idxen offen lds
    v_pk_fma_f32 v[2:3], v[2:3], v[54:55], v[2:3]
    v_pk_fma_f32 v[4:5], v[6:7], v[54:55], v[6:7]
    v_pk_fma_f32 v[2:3], v[22:23], v[6:7], v[2:3]
    v_pk_fma_f32 v[2:3], v[2:3], v[56:57], v[2:3]
    v_pk_fma_f32 v[6:7], v[4:5], v[56:57], v[4:5]
    v_pk_fma_f32 v[2:3], v[24:25], v[4:5], v[2:3]
    v_pk_fma_f32 v[2:3], v[2:3], v[58:59], v[2:3]
    v_pk_fma_f32 v[4:5], v[6:7], v[58:59], v[6:7]
    v_pk_fma_f32 v[2:3], v[26:27], v[6:7], v[2:3]
    v_pk_fma_f32 v[2:3], v[2:3], v[60:61], v[2:3]
    v_pk_fma_f32 v[6:7], v[4:5], v[60:61], v[4:5]
    v_pk_fma_f32 v[2:3], v[28:29], v[4:5], v[2:3]
    v_pk_fma_f32 v[2:3], v[2:3], v[62:63], v[2:3]
    v_pk_fma_f32 v[4:5], v[6:7], v[62:63], v[6:7]
    v_pk_fma_f32 v[2:3], v[30:31], v[6:7], v[2:3]
    s_waitcnt lgkmcnt(0)
    v_mfma_f32_32x32x16_bf16 v[16:31], v[80:83], v[84:87], 0
    v_exp_f32 v48, v32
    v_exp_f32 v49, v33
    v_exp_f32 v50, v34
    v_exp_f32 v51, v35
    v_mfma_f32_32x32x16_bf16 v[16:31], v[64:67], v[92:95], v[16:31]
    v_exp_f32 v52, v36
    v_exp_f32 v53, v37
    v_exp_f32 v54, v38
    v_exp_f32 v55, v39
    v_mfma_f32_32x32x16_bf16 v[16:31], v[68:71], v[96:99], v[16:31]
    v_exp_f32 v56, v40
    v_exp_f32 v57, v41
    v_exp_f32 v58, v42
    v_exp_f32 v59, v43
    v_exp_f32 v60, v44
    v_exp_f32 v61, v45
    v_exp_f32 v62, v46
    v_exp_f32 v63, v47
    v_pk_fma_f32 v[8:9], v[8:9], v[48:49], v[8:9]
    v_pk_fma_f32 v[6:7], v[10:11], v[48:49], v[10:11]
    v_pk_fma_f32 v[8:9], v[32:33], v[10:11], v[8:9]
    v_pk_fma_f32 v[8:9], v[8:9], v[50:51], v[8:9]
    v_pk_fma_f32 v[10:11], v[6:7], v[50:51], v[6:7]
    v_pk_fma_f32 v[8:9], v[34:35], v[6:7], v[8:9]
    v_pk_fma_f32 v[8:9], v[8:9], v[52:53], v[8:9]
    v_pk_fma_f32 v[6:7], v[10:11], v[52:53], v[10:11]
    v_pk_fma_f32 v[8:9], v[36:37], v[10:11], v[8:9]
    v_pk_fma_f32 v[8:9], v[8:9], v[54:55], v[8:9]
    v_pk_fma_f32 v[10:11], v[6:7], v[54:55], v[6:7]
    v_pk_fma_f32 v[8:9], v[38:39], v[6:7], v[8:9]
    v_pk_fma_f32 v[8:9], v[8:9], v[56:57], v[8:9]
    v_pk_fma_f32 v[6:7], v[10:11], v[56:57], v[10:11]
    v_pk_fma_f32 v[8:9], v[40:41], v[10:11], v[8:9]
    v_pk_fma_f32 v[8:9], v[8:9], v[58:59], v[8:9]
    v_pk_fma_f32 v[10:11], v[6:7], v[58:59], v[6:7]
    v_pk_fma_f32 v[8:9], v[42:43], v[6:7], v[8:9]
    v_pk_fma_f32 v[8:9], v[8:9], v[60:61], v[8:9]
    v_pk_fma_f32 v[6:7], v[10:11], v[60:61], v[10:11]
    v_pk_fma_f32 v[8:9], v[44:45], v[10:11], v[8:9]
    v_pk_fma_f32 v[8:9], v[8:9], v[62:63], v[8:9]
    v_pk_fma_f32 v[10:11], v[6:7], v[62:63], v[6:7]
    v_pk_fma_f32 v[8:9], v[46:47], v[6:7], v[8:9]
    s_cmp_eq_u32 s48, 0
    s_cbranch_scc1 K2_SN0
    ds_read_u16 v104, v124 offset:0
    ds_read_u16 v106, v124 offset:4
    ds_read_u16 v108, v124 offset:8
    ds_read_u16 v110, v124 offset:12
    ds_read_b32 v124, v112 offset:512
K2_SN0:
    v_mfma_f32_32x32x16_bf16 v[32:47], v[80:83], v[88:91], 0
    v_exp_f32 v48, v16
    v_exp_f32 v49, v17
    v_exp_f32 v50, v18
    v_exp_f32 v51, v19
    v_mfma_f32_32x32x16_bf16 v[32:47], v[72:75], v[92:95], v[32:47]
    v_exp_f32 v52, v20
    v_exp_f32 v53, v21
    v_exp_f32 v54, v22
    v_exp_f32 v55, v23
    v_mfma_f32_32x32x16_bf16 v[32:47], v[76:79], v[96:99], v[32:47]
    v_exp_f32 v56, v24
    v_exp_f32 v57, v25
    v_exp_f32 v58, v26
    v_exp_f32 v59, v27
    v_exp_f32 v60, v28
    v_exp_f32 v61, v29
    v_exp_f32 v62, v30
    v_exp_f32 v63, v31
    s_waitcnt vmcnt(0) lgkmcnt(0)
    ds_read_b128 v[64:67], v100
    ds_read_b128 v[68:71], v101
    ds_read_b128 v[72:75], v102
    ds_read_b128 v[76:79], v103
    v_add_u32 v124, v124, v116
    ds_read_u16 v82, v13 offset:192
    v_pk_fma_f32 v[2:3], v[2:3], v[48:49], v[2:3]
    v_pk_fma_f32 v[6:7], v[4:5], v[48:49], v[4:5]
    v_pk_fma_f32 v[2:3], v[16:17], v[4:5], v[2:3]
    v_pk_fma_f32 v[2:3], v[2:3], v[50:51], v[2:3]
    v_pk_fma_f32 v[4:5], v[6:7], v[50:51], v[6:7]
    v_pk_fma_f32 v[2:3], v[18:19], v[6:7], v[2:3]
    v_pk_fma_f32 v[2:3], v[2:3], v[52:53], v[2:3]
    v_pk_fma_f32 v[6:7], v[4:5], v[52:53], v[4:5]
    v_pk_fma_f32 v[2:3], v[20:21], v[4:5], v[2:3]
    s_cmp_lt_u32 s48, 1
    s_cbranch_scc1 K2_SND5
    s_waitcnt lgkmcnt(1)
    s_mov_b32 m0, s47
    s_nop 0
    buffer_load_dwordx4 v[104:105], s[32:35], 0 idxen offen lds
    s_add_u32 m0, s47, 1024
    s_nop 0
    buffer_load_dwordx4 v[106:107], s[32:35], 0 idxen offen lds
    s_add_u32 m0, s47, 2048
    s_nop 0
    buffer_load_dwordx4 v[108:109], s[32:35], 0 idxen offen lds
    s_add_u32 m0, s47, 3072
    s_nop 0
    buffer_load_dwordx4 v[110:111], s[32:35], 0 idxen offen lds
K2_SND5:
    v_pk_fma_f32 v[2:3], v[2:3], v[54:55], v[2:3]
    v_pk_fma_f32 v[4:5], v[6:7], v[54:55], v[6:7]
    v_pk_fma_f32 v[2:3], v[22:23], v[6:7], v[2:3]
    v_pk_fma_f32 v[2:3], v[2:3], v[56:57], v[2:3]
    v_pk_fma_f32 v[6:7], v[4:5], v[56:57], v[4:5]
    v_pk_fma_f32 v[2:3], v[24:25], v[4:5], v[2:3]
    v_pk_fma_f32 v[2:3], v[2:3], v[58:59], v[2:3]
    v_pk_fma_f32 v[4:5], v[6:7], v[58:59], v[6:7]
    v_pk_fma_f32 v[2:3], v[26:27], v[6:7], v[2:3]
    v_pk_fma_f32 v[2:3], v[2:3], v[60:61], v[2:3]
    v_pk_fma_f32 v[6:7], v[4:5], v[60:61], v[4:5]
    v_pk_fma_f32 v[2:3], v[28:29], v[4:5], v[2:3]
    v_pk_fma_f32 v[2:3], v[2:3], v[62:63], v[2:3]
    v_pk_fma_f32 v[4:5], v[6:7], v[62:63], v[6:7]
    v_pk_fma_f32 v[2:3], v[30:31], v[6:7], v[2:3]
    s_waitcnt lgkmcnt(0)
    v_mfma_f32_32x32x16_bf16 v[16:31], v[80:83], v[84:87], 0
    v_exp_f32 v48, v32
    v_exp_f32 v49, v33
    v_exp_f32 v50, v34
    v_exp_f32 v51, v35
    v_mfma_f32_32x32x16_bf16 v[16:31], v[64:67], v[92:95], v[16:31]
    v_exp_f32 v52, v36
    v_exp_f32 v53, v37
    v_exp_f32 v54, v38
    v_exp_f32 v55, v39
    v_mfma_f32_32x32x16_bf16 v[16:31], v[68:71], v[96:99], v[16:31]
    v_exp_f32 v56, v40
    v_exp_f32 v57, v41
    v_exp_f32 v58, v42
    v_exp_f32 v59, v43
    v_exp_f32 v60, v44
    v_exp_f32 v61, v45
    v_exp_f32 v62, v46
    v_exp_f32 v63, v47
    v_pk_fma_f32 v[8:9], v[8:9], v[48:49], v[8:9]
    v_pk_fma_f32 v[6:7], v[10:11], v[48:49], v[10:11]
    v_pk_fma_f32 v[8:9], v[32:33], v[10:11], v[8:9]
    v_pk_fma_f32 v[8:9], v[8:9], v[50:51], v[8:9]
    v_pk_fma_f32 v[10:11], v[6:7], v[50:51], v[6:7]
    v_pk_fma_f32 v[8:9], v[34:35], v[6:7], v[8:9]
    v_pk_fma_f32 v[8:9], v[8:9], v[52:53], v[8:9]
    v_pk_fma_f32 v[6:7], v[10:11], v[52:53], v[10:11]
    v_pk_fma_f32 v[8:9], v[36:37], v[10:11], v[8:9]
    v_pk_fma_f32 v[8:9], v[8:9], v[54:55], v[8:9]
    v_pk_fma_f32 v[10:11], v[6:7], v[54:55], v[6:7]
    v_pk_fma_f32 v[8:9], v[38:39], v[6:7], v[8:9]
    v_pk_fma_f32 v[8:9], v[8:9], v[56:57], v[8:9]
    v_pk_fma_f32 v[6:7], v[10:11], v[56:57], v[10:11]
    v_pk_fma_f32 v[8:9], v[40:41], v[10:11], v[8:9]
    v_pk_fma_f32 v[8:9], v[8:9], v[58:59], v[8:9]
    v_pk_fma_f32 v[10:11], v[6:7], v[58:59], v[6:7]
    v_pk_fma_f32 v[8:9], v[42:43], v[6:7], v[8:9]
    v_pk_fma_f32 v[8:9], v[8:9], v[60:61], v[8:9]
    v_pk_fma_f32 v[6:7], v[10:11], v[60:61], v[10:11]
    v_pk_fma_f32 v[8:9], v[44:45], v[10:11], v[8:9]
    v_pk_fma_f32 v[8:9], v[8:9], v[62:63], v[8:9]
    v_pk_fma_f32 v[10:11], v[6:7], v[62:63], v[6:7]
    v_pk_fma_f32 v[8:9], v[46:47], v[6:7], v[8:9]
    s_setprio 0
    s_cmp_eq_u32 s48, 0
    s_cbranch_scc1 K2_SLAST0
    ds_read_b32 v125, v113
    ds_read2_b32 v[122:123], v114 offset0:0 offset1:2
    s_cmp_lt_u32 s48, 2
    s_cbranch_scc1 K2_SN1
    ds_read_u16 v104, v124 offset:0
    ds_read_u16 v106, v124 offset:4
    ds_read_u16 v108, v124 offset:8
    ds_read_u16 v110, v124 offset:12
    ds_read_b32 v124, v112 offset:1024
K2_SN1:
    v_mfma_f32_32x32x16_bf16 v[32:47], v[80:83], v[88:91], 0
    v_exp_f32 v48, v16
    v_exp_f32 v49, v17
    v_exp_f32 v50, v18
    v_exp_f32 v51, v19
    v_mfma_f32_32x32x16_bf16 v[32:47], v[72:75], v[92:95], v[32:47]
    v_exp_f32 v52, v20
    v_exp_f32 v53, v21
    v_exp_f32 v54, v22
    v_exp_f32 v55, v23
    v_mfma_f32_32x32x16_bf16 v[32:47], v[76:79], v[96:99], v[32:47]
    v_exp_f32 v56, v24
    v_exp_f32 v57, v25
    v_exp_f32 v58, v26
    v_exp_f32 v59, v27
    v_exp_f32 v60, v28
    v_exp_f32 v61, v29
    v_exp_f32 v62, v30
    v_exp_f32 v63, v31
    s_waitcnt vmcnt(0) lgkmcnt(0)
    ds_read_b128 v[64:67], v100
    ds_read_b128 v[68:71], v101
    ds_read_b128 v[72:75], v102
    ds_read_b128 v[76:79], v103
    v_add_u32 v124, v124, v116
    v_add_u32 v125, v125, v117
    v_add_u32 v118, v122, v115
    v_add_u32 v119, v123, v115
    v_add_u32 v114, 512, v114
    ds_read_u16 v82, v125
    ds_read_b32 v84, v118 offset:27040
    ds_read_b32 v85, v119 offset:27040
    ds_read_b32 v88, v118 offset:27296
    ds_read_b32 v89, v119 offset:27296
    v_pk_fma_f32 v[2:3], v[2:3], v[48:49], v[2:3]
    v_pk_fma_f32 v[6:7], v[4:5], v[48:49], v[4:5]
    v_pk_fma_f32 v[2:3], v[16:17], v[4:5], v[2:3]
    v_pk_fma_f32 v[2:3], v[2:3], v[50:51], v[2:3]
    v_pk_fma_f32 v[4:5], v[6:7], v[50:51], v[6:7]
    v_pk_fma_f32 v[2:3], v[18:19], v[6:7], v[2:3]
    v_pk_fma_f32 v[2:3], v[2:3], v[52:53], v[2:3]
    v_pk_fma_f32 v[6:7], v[4:5], v[52:53], v[4:5]
    v_pk_fma_f32 v[2:3], v[20:21], v[4:5], v[2:3]
    s_cmp_lt_u32 s48, 2
    s_cbranch_scc1 K2_SND6
    s_waitcnt lgkmcnt(5)
    s_mov_b32 m0, s47
    s_nop 0
    buffer_load_dwordx4 v[104:105], s[32:35], 0 idxen offen lds
    s_add_u32 m0, s47, 1024
    s_nop 0
    buffer_load_dwordx4 v[106:107], s[32:35], 0 idxen offen lds
    s_add_u32 m0, s47, 2048
    s_nop 0
    buffer_load_dwordx4 v[108:109], s[32:35], 0 idxen offen lds
    s_add_u32 m0, s47, 3072
    s_nop 0
    buffer_load_dwordx4 v[110:111], s[32:35], 0 idxen offen lds
K2_SND6:
    v_pk_fma_f32 v[2:3], v[2:3], v[54:55], v[2:3]
    v_pk_fma_f32 v[4:5], v[6:7], v[54:55], v[6:7]
    v_pk_fma_f32 v[2:3], v[22:23], v[6:7], v[2:3]
    v_pk_fma_f32 v[2:3], v[2:3], v[56:57], v[2:3]
    v_pk_fma_f32 v[6:7], v[4:5], v[56:57], v[4:5]
    v_pk_fma_f32 v[2:3], v[24:25], v[4:5], v[2:3]
    v_pk_fma_f32 v[2:3], v[2:3], v[58:59], v[2:3]
    v_pk_fma_f32 v[4:5], v[6:7], v[58:59], v[6:7]
    v_pk_fma_f32 v[2:3], v[26:27], v[6:7], v[2:3]
    v_pk_fma_f32 v[2:3], v[2:3], v[60:61], v[2:3]
    v_pk_fma_f32 v[6:7], v[4:5], v[60:61], v[4:5]
    v_pk_fma_f32 v[2:3], v[28:29], v[4:5], v[2:3]
    v_pk_fma_f32 v[2:3], v[2:3], v[62:63], v[2:3]
    v_pk_fma_f32 v[4:5], v[6:7], v[62:63], v[6:7]
    v_pk_fma_f32 v[2:3], v[30:31], v[6:7], v[2:3]
    s_waitcnt lgkmcnt(0)
    v_mfma_f32_32x32x16_bf16 v[16:31], v[80:83], v[84:87], 0
    v_exp_f32 v48, v32
    v_exp_f32 v49, v33
    v_exp_f32 v50, v34
    v_exp_f32 v51, v35
    v_mfma_f32_32x32x16_bf16 v[16:31], v[64:67], v[92:95], v[16:31]
    v_exp_f32 v52, v36
    v_exp_f32 v53, v37
    v_exp_f32 v54, v38
    v_exp_f32 v55, v39
    v_mfma_f32_32x32x16_bf16 v[16:31], v[68:71], v[96:99], v[16:31]
    v_exp_f32 v56, v40
    v_exp_f32 v57, v41
    v_exp_f32 v58, v42
    v_exp_f32 v59, v43
    v_exp_f32 v60, v44
    v_exp_f32 v61, v45
    v_exp_f32 v62, v46
    v_exp_f32 v63, v47
    v_pk_fma_f32 v[8:9], v[8:9], v[48:49], v[8:9]
    v_pk_fma_f32 v[6:7], v[10:11], v[48:49], v[10:11]
    v_pk_fma_f32 v[8:9], v[32:33], v[10:11], v[8:9]
    v_pk_fma_f32 v[8:9], v[8:9], v[50:51], v[8:9]
    v_pk_fma_f32 v[10:11], v[6:7], v[50:51], v[6:7]
    v_pk_fma_f32 v[8:9], v[34:35], v[6:7], v[8:9]
    v_pk_fma_f32 v[8:9], v[8:9], v[52:53], v[8:9]
    v_pk_fma_f32 v[6:7], v[10:11], v[52:53], v[10:11]
    v_pk_fma_f32 v[8:9], v[36:37], v[10:11], v[8:9]
    v_pk_fma_f32 v[8:9], v[8:9], v[54:55], v[8:9]
    v_pk_fma_f32 v[10:11], v[6:7], v[54:55], v[6:7]
    v_pk_fma_f32 v[8:9], v[38:39], v[6:7], v[8:9]
    v_pk_fma_f32 v[8:9], v[8:9], v[56:57], v[8:9]
    v_pk_fma_f32 v[6:7], v[10:11], v[56:57], v[10:11]
    v_pk_fma_f32 v[8:9], v[40:41], v[10:11], v[8:9]
    v_pk_fma_f32 v[8:9], v[8:9], v[58:59], v[8:9]
    v_pk_fma_f32 v[10:11], v[6:7], v[58:59], v[6:7]
    v_pk_fma_f32 v[8:9], v[42:43], v[6:7], v[8:9]
    v_pk_fma_f32 v[8:9], v[8:9], v[60:61], v[8:9]
    v_pk_fma_f32 v[6:7], v[10:11], v[60:61], v[10:11]
    v_pk_fma_f32 v[8:9], v[44:45], v[10:11], v[8:9]
    v_pk_fma_f32 v[8:9], v[8:9], v[62:63], v[8:9]
    v_pk_fma_f32 v[10:11], v[6:7], v[62:63], v[6:7]
    v_pk_fma_f32 v[8:9], v[46:47], v[6:7], v[8:9]
    v_rcp_f32 v48, v4
    v_rcp_f32 v49, v5
    v_max3_f32 v126, v4, v5, v126
    v_pk_mul_f32 v[2:3], v[2:3], v[48:49]
    v_cvt_f64_f32 v[50:51], v2
    v_cvt_f64_f32 v[52:53], v3
    ds_add_f64 v120, v[50:51] offset:640
    ds_add_f64 v121, v[52:53] offset:640
    v_rcp_f32 v48, v10
    v_rcp_f32 v49, v11
    v_max3_f32 v126, v10, v11, v126
    v_pk_mul_f32 v[8:9], v[8:9], v[48:49]
    v_cvt_f64_f32 v[54:55], v8
    v_cvt_f64_f32 v[56:57], v9
    ds_add_f64 v120, v[54:55] offset:896
    ds_add_f64 v121, v[56:57] offset:896
    v_add_f32 v48, abs(v2), abs(v3)
    v_add_f32 v49, abs(v8), abs(v9)
    v_add_f32 v48, v48, v49
    v_mul_f32 v48, 0, v48
    v_add_f32 v126, v126, v48
    s_branch K2_F_LOOP0
K2_SLAST0:
    v_mfma_f32_32x32x16_bf16 v[32:47], v[80:83], v[88:91], 0
    v_exp_f32 v48, v16
    v_exp_f32 v49, v17
    v_exp_f32 v50, v18
    v_exp_f32 v51, v19
    v_mfma_f32_32x32x16_bf16 v[32:47], v[72:75], v[92:95], v[32:47]
    v_exp_f32 v52, v20
    v_exp_f32 v53, v21
    v_exp_f32 v54, v22
    v_exp_f32 v55, v23
    v_mfma_f32_32x32x16_bf16 v[32:47], v[76:79], v[96:99], v[32:47]
    v_exp_f32 v56, v24
    v_exp_f32 v57, v25
    v_exp_f32 v58, v26
    v_exp_f32 v59, v27
    v_exp_f32 v60, v28
    v_exp_f32 v61, v29
    v_exp_f32 v62, v30
    v_exp_f32 v63, v31
    v_pk_fma_f32 v[2:3], v[2:3], v[48:49], v[2:3]
    v_pk_fma_f32 v[6:7], v[4:5], v[48:49], v[4:5]
    v_pk_fma_f32 v[2:3], v[16:17], v[4:5], v[2:3]
    v_pk_fma_f32 v[2:3], v[2:3], v[50:51], v[2:3]
    v_pk_fma_f32 v[4:5], v[6:7], v[50:51], v[6:7]
    v_pk_fma_f32 v[2:3], v[18:19], v[6:7], v[2:3]
    v_pk_fma_f32 v[2:3], v[2:3], v[52:53], v[2:3]
    v_pk_fma_f32 v[6:7], v[4:5], v[52:53], v[4:5]
    v_pk_fma_f32 v[2:3], v[20:21], v[4:5], v[2:3]
    v_pk_fma_f32 v[2:3], v[2:3], v[54:55], v[2:3]
    v_pk_fma_f32 v[4:5], v[6:7], v[54:55], v[6:7]
    v_pk_fma_f32 v[2:3], v[22:23], v[6:7], v[2:3]
    v_pk_fma_f32 v[2:3], v[2:3], v[56:57], v[2:3]
    v_pk_fma_f32 v[6:7], v[4:5], v[56:57], v[4:5]
    v_pk_fma_f32 v[2:3], v[24:25], v[4:5], v[2:3]
    v_pk_fma_f32 v[2:3], v[2:3], v[58:59], v[2:3]
    v_pk_fma_f32 v[4:5], v[6:7], v[58:59], v[6:7]
    v_pk_fma_f32 v[2:3], v[26:27], v[6:7], v[2:3]
    v_pk_fma_f32 v[2:3], v[2:3], v[60:61], v[2:3]
    v_pk_fma_f32 v[6:7], v[4:5], v[60:61], v[4:5]
    v_pk_fma_f32 v[2:3], v[28:29], v[4:5], v[2:3]
    v_pk_fma_f32 v[2:3], v[2:3], v[62:63], v[2:3]
    v_pk_fma_f32 v[4:5], v[6:7], v[62:63], v[6:7]
    v_pk_fma_f32 v[2:3], v[30:31], v[6:7], v[2:3]
    v_exp_f32 v48, v32
    v_exp_f32 v49, v33
    v_exp_f32 v50, v34
    v_exp_f32 v51, v35
    v_exp_f32 v52, v36
    v_exp_f32 v53, v37
    v_exp_f32 v54, v38
    v_exp_f32 v55, v39
    v_exp_f32 v56, v40
    v_exp_f32 v57, v41
    v_exp_f32 v58, v42
    v_exp_f32 v59, v43
    v_exp_f32 v60, v44
    v_exp_f32 v61, v45
    v_exp_f32 v62, v46
    v_exp_f32 v63, v47
    v_pk_fma_f32 v[8:9], v[8:9], v[48:49], v[8:9]
    v_pk_fma_f32 v[6:7], v[10:11], v[48:49], v[10:11]
    v_pk_fma_f32 v[8:9], v[32:33], v[10:11], v[8:9]
    v_pk_fma_f32 v[8:9], v[8:9], v[50:51], v[8:9]
    v_pk_fma_f32 v[10:11], v[6:7], v[50:51], v[6:7]
    v_pk_fma_f32 v[8:9], v[34:35], v[6:7], v[8:9]
    v_pk_fma_f32 v[8:9], v[8:9], v[52:53], v[8:9]
    v_pk_fma_f32 v[6:7], v[10:11], v[52:53], v[10:11]
    v_pk_fma_f32 v[8:9], v[36:37], v[10:11], v[8:9]
    v_pk_fma_f32 v[8:9], v[8:9], v[54:55], v[8:9]
    v_pk_fma_f32 v[10:11], v[6:7], v[54:55], v[6:7]
    v_pk_fma_f32 v[8:9], v[38:39], v[6:7], v[8:9]
    v_pk_fma_f32 v[8:9], v[8:9], v[56:57], v[8:9]
    v_pk_fma_f32 v[6:7], v[10:11], v[56:57], v[10:11]
    v_pk_fma_f32 v[8:9], v[40:41], v[10:11], v[8:9]
    v_pk_fma_f32 v[8:9], v[8:9], v[58:59], v[8:9]
    v_pk_fma_f32 v[10:11], v[6:7], v[58:59], v[6:7]
    v_pk_fma_f32 v[8:9], v[42:43], v[6:7], v[8:9]
    v_pk_fma_f32 v[8:9], v[8:9], v[60:61], v[8:9]
    v_pk_fma_f32 v[6:7], v[10:11], v[60:61], v[10:11]
    v_pk_fma_f32 v[8:9], v[44:45], v[10:11], v[8:9]
    v_pk_fma_f32 v[8:9], v[8:9], v[62:63], v[8:9]
    v_pk_fma_f32 v[10:11], v[6:7], v[62:63], v[6:7]
    v_pk_fma_f32 v[8:9], v[46:47], v[6:7], v[8:9]
    v_rcp_f32 v48, v4
    v_rcp_f32 v49, v5
    v_max3_f32 v126, v4, v5, v126
    v_pk_mul_f32 v[2:3], v[2:3], v[48:49]
    v_cvt_f64_f32 v[50:51], v2
    v_cvt_f64_f32 v[52:53], v3
    ds_add_f64 v120, v[50:51] offset:640
    ds_add_f64 v121, v[52:53] offset:640
    v_rcp_f32 v48, v10
    v_rcp_f32 v49, v11
    v_max3_f32 v126, v10, v11, v126
    v_pk_mul_f32 v[8:9], v[8:9], v[48:49]
    v_cvt_f64_f32 v[54:55], v8
    v_cvt_f64_f32 v[56:57], v9
    ds_add_f64 v120, v[54:55] offset:896
    ds_add_f64 v121, v[56:57] offset:896
    v_add_f32 v48, abs(v2), abs(v3)
    v_add_f32 v49, abs(v8), abs(v9)
    v_add_f32 v48, v48, v49
    v_mul_f32 v48, 0, v48
    v_add_f32 v126, v126, v48
    s_branch K2_LOOPDONE
K2_HELP:
    s_sub_u32 s53, s46, 12
    v_lshlrev_b32 v13, 4, v1
    v_lshrrev_b32 v5, 3, v1
    v_and_b32 v6, 7, v1
    v_xor_b32 v6, v6, v5
    v_lshlrev_b32 v6, 4, v6
    v_lshl_add_u32 v6, v5, 7, v6
    s_mul_i32 s45, s44, 49
    s_lshl_b32 s3, s53, 11
    s_lshl_b32 s84, s45, 7
    s_add_u32 s84, s84, s3
    v_add_u32 v6, s84, v6
    v_mov_b32 v12, v6
    v_mov_b32 v4, 0
    v_mov_b32 v5, 0
    v_mov_b32 v6, 0
    v_mov_b32 v7, 0
    v_mul_u32_u24 v3, 12, v1
    v_mul_u32_u24 v8, 112, v1
    v_add_u32 v8, 13360, v8
    s_mov_b32 exec_lo, -1
    s_mov_b32 exec_hi, 0x3ffff
    ds_write2_b32 v3, v4, v8 offset0:4 offset1:5
    ds_write_b32 v3, v4 offset:24
    ds_write_b128 v4, v[4:7] offset:0
    v_mov_b32 v3, 624
    ds_write_b128 v3, v[4:7]
    s_mov_b64 exec, -1
    s_add_u32 m0, s3, 81472
    s_waitcnt lgkmcnt(0)
    s_add_u32 s8, s14, 2621440
    s_addc_u32 s9, s15, 0
    s_mov_b32 s10, 32768
    s_mov_b32 s11, 0x00020000
    s_cmp_eq_u32 s53, 3
    buffer_load_dwordx4 v13, s[8:11], s3 offen lds
    s_cselect_b32 exec_hi, 0, -1
    buffer_load_dwordx4 v13, s[8:11], s3 offen offset:1024 lds
    s_mov_b64 exec, -1
    s_add_u32 m0, s3, 105600
    s_mov_b32 s16, s4
    s_mov_b32 s17, s5
    s_mov_b32 s18, 1600000
    s_mov_b32 s19, 0x00020000
    buffer_load_dwordx4 v12, s[16:19], 0 offen lds
    buffer_load_dwordx4 v12, s[16:19], 0 offen offset:1024 lds
    s_add_u32 m0, s3, 89216
    s_add_u32 s4, s3, 8192
    buffer_load_dwordx4 v13, s[8:11], s4 offen offset:0 lds
    buffer_load_dwordx4 v13, s[8:11], s4 offen offset:1024 lds
    s_barrier
    s_add_u32 s20, s14, 4096
    s_addc_u32 s21, s15, 0
    s_mov_b32 s22, 1600000
    s_mov_b32 s23, 0x00020000
    s_mov_b32 s32, s20
    s_or_b32 s33, s21, 8388608
    s_mov_b32 s34, 12500
    s_mov_b32 s35, 0x00020000
    s_mov_b32 s28, s12
    s_mov_b32 s29, s13
    s_mov_b32 s30, 1600000
    s_mov_b32 s31, 0x00020000
    s_add_u32 s40, s14, 4194304
    s_addc_u32 s41, s15, 0
    s_mov_b32 s42, 4224000
    s_mov_b32 s43, 0x00020000
    s_mov_b32 s12, 0x2d800000
    s_mov_b32 s13, 0x2d800000
    s_movk_i32 s6, 112
    s_mov_b32 s7, 53440
    s_mov_b32 s51, 0
    s_mov_b32 s55, 0
    s_mov_b32 s50, 0
    s_mov_b32 s24, 7
    s_mov_b32 s25, 6
    s_mov_b32 s58, 1.0
    s_mov_b32 s59, 1.0
    s_lshl_b32 s47, s46, 12
    s_add_u32 s47, s47, 89216
    s_mul_i32 s45, s44, 49
    v_subrev_u32 v2, 768, v0
    v_lshlrev_b32 v2, 4, v2
    v_mov_b32 v4, 0xffff
    v_mov_b32 v5, 0xffff
    v_mov_b32 v6, 0xffff
    v_mov_b32 v7, 0xffff
    ds_write_b128 v2, v[4:7] offset:53440
    ds_write_b128 v2, v[4:7] offset:57536
    ds_write_b128 v2, v[4:7] offset:61632
    v_add_u32 v3, 53440, v2
    ds_write_b128 v3, v[4:7] offset:12288
    ds_write_b128 v3, v[4:7] offset:16384
    v_mov_b32 v8, 1920
    v_cmpx_lt_u32 vcc, v2, v8
    ds_write_b128 v3, v[4:7] offset:20480
    s_mov_b64 exec, -1
    v_mov_b32 v4, 0
    v_mov_b32 v5, 0
    v_mov_b32 v6, 0
    v_mov_b32 v7, 0
    v_lshrrev_b32 v8, 4, v1
    v_lshl_add_u32 v8, s46, 2, v8
    v_mul_u32_u24 v9, 448, v8
    v_lshlrev_b32 v11, 1, v1
    v_and_b32 v11, 16, v11
    v_add3_u32 v12, v9, v11, s7
    v_bfe_u32 v8, v1, 4, 1
    v_lshrrev_b32 v9, 5, v1
    v_lshl_or_b32 v8, v9, 2, v8
    v_and_b32 v9, 7, v1
    v_xor_b32 v8, v8, v9
    v_lshlrev_b32 v105, 4, v8
    v_xor_b32 v107, 32, v105
    v_mov_b32 v109, v105
    v_mov_b32 v111, v107
    v_mov_b32 v104, -1
    v_mov_b32 v106, -1
    v_mov_b32 v108, -1
    v_mov_b32 v110, -1
    v_min_u32 v12, 48, v1
    v_mul_u32_u24 v13, 12, v12
    v_cmp_gt_u32 s[84:85], 48, v1
    v_mul_u32_u24 v27, 528, v12
    v_mul_u32_u24 v26, 448, v12
    v_lshrrev_b32 v28, 2, v26
    v_add_u32 v28, 13360, v28
    v_subrev_u32 v29, 48, v1
    v_mov_b32 v11, s24
    v_cndmask_b32 v12, v29, v11, s[84:85]
    v_cndmask_b32 v24, 1, 14, s[84:85]
    v_lshl_add_u32 v26, v12, 5, v26
    v_add_u32 v26, s7, v26
    s_lshl_b32 s60, s25, 4
    s_mul_i32 s61, s25, 384
    s_add_u32 s61, s61, 75840
    v_mov_b32 v5, 4
    v_mov_b32 v8, 1
    s_waitcnt vmcnt(4)
    s_mov_b64 exec, 1
    ds_add_u32 v5, v8
    s_mov_b64 exec, -1
    v_lshrrev_b32 v7, 4, v1
    v_and_b32 v25, 15, v1
    s_lshl_b32 s3, s53, 4
    v_add_u32 v25, s3, v25
    v_mul_u32_u24 v6, 528, v25
    v_lshl_add_u32 v6, v7, 5, v6
    v_mul_u32_u24 v10, 12, v25
    v_cmp_gt_u32 s[86:87], 50, v25
    v_lshlrev_b32 v3, 4, v1
    v_add_u32 v14, 81472, v3
    v_and_b32 v2, 7, v1
    v_xor_b32 v2, v2, v7
    v_lshlrev_b32 v2, 4, v2
    v_lshl_add_u32 v2, v25, 7, v2
    v_add_u32 v2, 105600, v2
    v_xor_b32 v4, 64, v2
    v_add_u32 v3, 89216, v3
    v_mov_b32 v5, 0
    v_mov_b32 v8, 1
    s_waitcnt vmcnt(0)
    s_mov_b64 exec, 1
    ds_add_u32 v5, v8
    s_mov_b64 exec, -1
    v_mov_b32 v5, 0
K2_QPOLL:
    ds_read_b32 v8, v5
    s_waitcnt lgkmcnt(0)
    v_readfirstlane_b32 s3, v8
    s_cmp_lt_u32 s3, 4
    s_cbranch_scc1 K2_QPOLL
    ds_read_b128 v[16:19], v2
    ds_read_b128 v[20:23], v4
    ds_read_b128 v[32:35], v3 offset:0
    ds_read_b128 v[36:39], v3 offset:1024
    ds_read_b128 v[40:43], v3 offset:2048
    ds_read_b128 v[44:47], v3 offset:3072
    ds_read_b128 v[48:51], v3 offset:4096
    ds_read_b128 v[52:55], v3 offset:5120
    ds_read_b128 v[56:59], v3 offset:6144
    ds_read_b128 v[60:63], v3 offset:7168
    s_mov_b32 s84, 0xbfb8aa3b
    s_mov_b32 s85, 0xbfb8aa3b
    s_mov_b32 s3, 0x05040100
    s_mov_b32 s4, 0x07060302
    s_waitcnt lgkmcnt(0)
    v_mfma_f32_16x16x32_bf16 v[64:67], v[32:35], v[16:19], 0
    v_mfma_f32_16x16x32_bf16 v[68:71], v[40:43], v[16:19], 0
    v_mfma_f32_16x16x32_bf16 v[72:75], v[48:51], v[16:19], 0
    v_mfma_f32_16x16x32_bf16 v[76:79], v[56:59], v[16:19], 0
    v_mfma_f32_16x16x32_bf16 v[64:67], v[36:39], v[20:23], v[64:67]
    v_mfma_f32_16x16x32_bf16 v[68:71], v[44:47], v[20:23], v[68:71]
    v_mfma_f32_16x16x32_bf16 v[72:75], v[52:55], v[20:23], v[72:75]
    v_mfma_f32_16x16x32_bf16 v[76:79], v[60:63], v[20:23], v[76:79]
    s_nop 4
    v_pk_mul_f32 v[64:65], v[64:65], s[84:85]
    v_pk_mul_f32 v[66:67], v[66:67], s[84:85]
    v_pk_mul_f32 v[68:69], v[68:69], s[84:85]
    v_pk_mul_f32 v[70:71], v[70:71], s[84:85]
    v_pk_mul_f32 v[72:73], v[72:73], s[84:85]
    v_pk_mul_f32 v[74:75], v[74:75], s[84:85]
    s_nop 0
    v_pk_mul_f32 v[76:77], v[76:77], s[84:85]
    v_pk_mul_f32 v[78:79], v[78:79], s[84:85]
    s_mov_b32 s3, 0x05040100
    s_mov_b32 s4, 0x07060302
    v_cvt_pk_bf16_f32 v30, v64, v65
    v_lshlrev_b32 v16, 16, v30
    v_and_b32 v17, 0xffff0000, v30
    v_pk_add_f32 v[16:17], v[64:65], v[16:17] neg_lo:[0,1] neg_hi:[0,1]
    v_cvt_pk_bf16_f32 v16, v16, v17
    v_perm_b32 v32, v16, v30, s3
    v_perm_b32 v34, v16, v30, s4
    v_cvt_pk_bf16_f32 v30, v66, v67
    v_lshlrev_b32 v16, 16, v30
    v_and_b32 v17, 0xffff0000, v30
    v_pk_add_f32 v[16:17], v[66:67], v[16:17] neg_lo:[0,1] neg_hi:[0,1]
    v_cvt_pk_bf16_f32 v16, v16, v17
    v_perm_b32 v36, v16, v30, s3
    v_perm_b32 v38, v16, v30, s4
    s_mov_b64 exec, s[86:87]
    ds_write_b128 v6, v[32:35] offset:27040
    ds_write_b128 v6, v[36:39] offset:27056
    s_mov_b64 exec, -1
    v_cvt_pk_bf16_f32 v30, v68, v69
    v_lshlrev_b32 v16, 16, v30
    v_and_b32 v17, 0xffff0000, v30
    v_pk_add_f32 v[16:17], v[68:69], v[16:17] neg_lo:[0,1] neg_hi:[0,1]
    v_cvt_pk_bf16_f32 v16, v16, v17
    v_perm_b32 v40, v16, v30, s3
    v_perm_b32 v42, v16, v30, s4
    v_cvt_pk_bf16_f32 v30, v70, v71
    v_lshlrev_b32 v16, 16, v30
    v_and_b32 v17, 0xffff0000, v30
    v_pk_add_f32 v[16:17], v[70:71], v[16:17] neg_lo:[0,1] neg_hi:[0,1]
    v_cvt_pk_bf16_f32 v16, v16, v17
    v_perm_b32 v44, v16, v30, s3
    v_perm_b32 v46, v16, v30, s4
    s_mov_b64 exec, s[86:87]
    ds_write_b128 v6, v[40:43] offset:27168
    ds_write_b128 v6, v[44:47] offset:27184
    s_mov_b64 exec, -1
    v_mov_b32 v126, 0
    v_mov_b32 v15, 0
K2_HPASS:
K2_HPASS2:
    s_waitcnt lgkmcnt(0)
    s_barrier
    ds_read2_b32 v[18:19], v13 offset0:5 offset1:6
    ds_read2_b32 v[22:23], v10 offset0:5 offset1:6
    s_waitcnt lgkmcnt(1)
    v_add_u32 v8, v18, v19
    v_sub_u32 v8, v8, v28
    v_cmp_lt_u32 vcc, s6, v8
    v_min_u32 v8, s6, v8
    v_add_u32 v8, 7, v8
    v_lshrrev_b32 v8, 3, v8
    v_sub_u32 v8, v8, v12 clamp
    v_min_u32 v8, v8, v24
    v_mov_b32 v11, v8
    s_cmp_lg_u64 vcc, 0
    s_cselect_b32 s52, 1, 0
    v_add_u32_dpp v11, v11, v11 row_shr:1 row_mask:0xf bank_mask:0xf
    s_nop 1
    v_add_u32_dpp v11, v11, v11 row_shr:2 row_mask:0xf bank_mask:0xf
    s_nop 1
    v_add_u32_dpp v11, v11, v11 row_shr:4 row_mask:0xf bank_mask:0xf
    s_nop 1
    v_add_u32_dpp v11, v11, v11 row_shr:8 row_mask:0xf bank_mask:0xf
    s_nop 1
    v_add_u32_dpp v11, v11, v11 row_bcast:15 row_mask:0xa bank_mask:0xf
    s_nop 1
    v_add_u32_dpp v11, v11, v11 row_bcast:31 row_mask:0xc bank_mask:0xf
    s_nop 1
    v_readlane_b32 s26, v11, 63
    v_sub_u32 v11, v11, v8
    v_add_u32 v11, s53, v11
    s_lshl_b32 s3, s53, 5
    v_add_u32 v26, s3, v26
    v_subrev_u32 v8, s53, v8
    v_cmpx_lt_i32 vcc, 0, v8
    s_nop 1
    s_cbranch_execz K2_BLD1
K2_BLD0:
    v_lshlrev_b32 v18, 3, v11
    v_and_b32 v19, 0x78, v18
    v_lshrrev_b32 v20, 4, v11
    v_lshl_add_u32 v19, v20, 9, v19
    v_cmp_gt_u32 s[84:85], s60, v11
    v_add_u32 v19, 76224, v19
    v_add_u32 v18, s61, v18
    v_cndmask_b32 v18, v18, v19, s[84:85]
    ds_write_b64 v18, v[26:27]
    v_add_u32 v26, 128, v26
    v_add_u32 v11, 4, v11
    v_subrev_u32 v8, 4, v8
    v_cmpx_lt_i32 vcc, 0, v8
    s_nop 1
    s_cbranch_execnz K2_BLD0
K2_BLD1:
    s_mov_b64 exec, -1
    s_add_u32 s3, s26, s53
    v_mov_b32 v11, s3
    v_mov_b32 v26, 75392
    v_mov_b32 v27, 25872
    v_lshlrev_b32 v18, 3, v11
    v_and_b32 v19, 0x78, v18
    v_lshrrev_b32 v20, 4, v11
    v_lshl_add_u32 v19, v20, 9, v19
    v_cmp_gt_u32 s[84:85], s60, v11
    v_add_u32 v19, 76224, v19
    v_add_u32 v18, s61, v18
    v_cndmask_b32 v18, v18, v19, s[84:85]
    ds_write_b64 v18, v[26:27]
    s_add_u32 s26, s26, 3
    s_lshr_b32 s26, s26, 2
    v_mov_b32 v18, s26
    v_mov_b32 v19, s52
    v_mov_b32 v20, 632
    ds_write_b64 v20, v[18:19]
    s_lshl_b32 s3, s25, 2
    s_add_u32 s3, s3, s46
    s_sub_i32 s48, s26, s3
    s_add_i32 s48, s48, 15
    s_max_i32 s48, s48, 0
    s_lshr_b32 s48, s48, 4
    s_sub_i32 s3, s26, s46
    s_add_i32 s3, s3, 15
    s_max_i32 s3, s3, 0
    s_lshr_b32 s3, s3, 2
    s_min_u32 s3, s3, s25
    s_mul_i32 s3, s3, s27
    s_add_u32 s48, s48, s3
    s_cmp_lg_u32 s55, 0
    s_cbranch_scc1 K2_NOLATE
    s_mov_b32 s3, 0x05040100
    s_mov_b32 s4, 0x07060302
    v_cvt_pk_bf16_f32 v30, v72, v73
    v_lshlrev_b32 v16, 16, v30
    v_and_b32 v17, 0xffff0000, v30
    v_pk_add_f32 v[16:17], v[72:73], v[16:17] neg_lo:[0,1] neg_hi:[0,1]
    v_cvt_pk_bf16_f32 v16, v16, v17
    v_perm_b32 v48, v16, v30, s3
    v_perm_b32 v50, v16, v30, s4
    v_cvt_pk_bf16_f32 v30, v74, v75
    v_lshlrev_b32 v16, 16, v30
    v_and_b32 v17, 0xffff0000, v30
    v_pk_add_f32 v[16:17], v[74:75], v[16:17] neg_lo:[0,1] neg_hi:[0,1]
    v_cvt_pk_bf16_f32 v16, v16, v17
    v_perm_b32 v52, v16, v30, s3
    v_perm_b32 v54, v16, v30, s4
    s_mov_b64 exec, s[86:87]
    ds_write_b128 v6, v[48:51] offset:27296
    ds_write_b128 v6, v[52:55] offset:27312
    s_mov_b64 exec, -1
    v_cvt_pk_bf16_f32 v30, v76, v77
    v_lshlrev_b32 v16, 16, v30
    v_and_b32 v17, 0xffff0000, v30
    v_pk_add_f32 v[16:17], v[76:77], v[16:17] neg_lo:[0,1] neg_hi:[0,1]
    v_cvt_pk_bf16_f32 v16, v16, v17
    v_perm_b32 v56, v16, v30, s3
    v_perm_b32 v58, v16, v30, s4
    v_cvt_pk_bf16_f32 v30, v78, v79
    v_lshlrev_b32 v16, 16, v30
    v_and_b32 v17, 0xffff0000, v30
    v_pk_add_f32 v[16:17], v[78:79], v[16:17] neg_lo:[0,1] neg_hi:[0,1]
    v_cvt_pk_bf16_f32 v16, v16, v17
    v_perm_b32 v60, v16, v30, s3
    v_perm_b32 v62, v16, v30, s4
    s_mov_b64 exec, s[86:87]
    ds_write_b128 v6, v[56:59] offset:27424
    ds_write_b128 v6, v[60:63] offset:27440
    s_mov_b64 exec, -1
K2_NOLATE:
    s_waitcnt lgkmcnt(0)
    s_barrier
K2_DYNHEAD:
    s_cmp_eq_u32 s27, 0
    s_cbranch_scc1 K2_NOCORR
    s_setprio 0
    v_lshlrev_b32 v3, 3, v1
    v_add_u32 v3, 86592, v3
    ds_read_b64 v[122:123], v3 offset:1536
    ds_read_b128 v[112:115], v14 offset:3072
    ds_read_b64 v[116:117], v3 offset:2048
    ds_read_b128 v[100:103], v14 offset:2048
    ds_read_b128 v[92:95], v14
    ds_read_b128 v[96:99], v14 offset:1024
    ds_read_b64 v[80:81], v3
    ds_read_b64 v[86:87], v3 offset:512
    ds_read_b64 v[90:91], v3 offset:1024
    v_mov_b32 v83, 0
    v_add_u32 v22, v22, v23
    v_mul_u32_u24 v23, 112, v25
    v_sub_u32 v22, v22, v23
    v_cmp_gt_u32 s[84:85], 48, v25
    v_subrev_u32 v22, 13360, v22
    s_lshl_b32 s3, s24, 3
    v_mov_b32 v23, s3
    v_min_u32 v22, s6, v22
    v_add_u32 v21, 7, v22
    v_cndmask_b32 v23, 0, v23, s[84:85]
    v_and_b32 v21, -8, v21
    v_max_u32 v21, v21, v23
    v_sub_u32 v21, v22, v21
    v_cvt_f32_i32 v21, v21
    v_exp_f32 v32, v64
    v_exp_f32 v33, v65
    v_exp_f32 v34, v66
    v_exp_f32 v35, v67
    v_exp_f32 v36, v68
    v_exp_f32 v37, v69
    v_exp_f32 v38, v70
    v_exp_f32 v39, v71
    v_exp_f32 v40, v72
    v_exp_f32 v41, v73
    v_exp_f32 v42, v74
    v_exp_f32 v43, v75
    v_exp_f32 v44, v76
    v_exp_f32 v45, v77
    v_exp_f32 v46, v78
    v_exp_f32 v47, v79
    v_pk_add_f32 v[32:33], v[32:33], s[58:59]
    v_pk_add_f32 v[34:35], v[34:35], s[58:59]
    v_pk_add_f32 v[36:37], v[36:37], s[58:59]
    v_pk_add_f32 v[38:39], v[38:39], s[58:59]
    v_pk_add_f32 v[40:41], v[40:41], s[58:59]
    v_pk_add_f32 v[42:43], v[42:43], s[58:59]
    v_pk_add_f32 v[44:45], v[44:45], s[58:59]
    v_pk_add_f32 v[46:47], v[46:47], s[58:59]
    v_rcp_f32 v32, v32
    v_rcp_f32 v33, v33
    v_rcp_f32 v34, v34
    v_rcp_f32 v35, v35
    v_rcp_f32 v36, v36
    v_rcp_f32 v37, v37
    v_rcp_f32 v38, v38
    v_rcp_f32 v39, v39
    v_rcp_f32 v40, v40
    v_rcp_f32 v41, v41
    v_rcp_f32 v42, v42
    v_rcp_f32 v43, v43
    v_rcp_f32 v44, v44
    v_rcp_f32 v45, v45
    v_rcp_f32 v46, v46
    v_rcp_f32 v47, v47
    v_pk_mul_f32 v[64:65], v[64:65], v[32:33]
    v_pk_mul_f32 v[66:67], v[66:67], v[34:35]
    v_pk_mul_f32 v[68:69], v[68:69], v[36:37]
    v_pk_mul_f32 v[70:71], v[70:71], v[38:39]
    v_pk_mul_f32 v[72:73], v[72:73], v[40:41]
    v_pk_mul_f32 v[74:75], v[74:75], v[42:43]
    v_pk_mul_f32 v[76:77], v[76:77], v[44:45]
    v_pk_mul_f32 v[78:79], v[78:79], v[46:47]
    s_mov_b64 exec, s[86:87]
    v_pk_mul_f32 v[64:65], v[64:65], v[20:21] op_sel:[0,1] op_sel_hi:[1,1]
    v_pk_mul_f32 v[66:67], v[66:67], v[20:21] op_sel:[0,1] op_sel_hi:[1,1]
    v_pk_mul_f32 v[68:69], v[68:69], v[20:21] op_sel:[0,1] op_sel_hi:[1,1]
    v_pk_mul_f32 v[70:71], v[70:71], v[20:21] op_sel:[0,1] op_sel_hi:[1,1]
    v_pk_mul_f32 v[72:73], v[72:73], v[20:21] op_sel:[0,1] op_sel_hi:[1,1]
    v_pk_mul_f32 v[74:75], v[74:75], v[20:21] op_sel:[0,1] op_sel_hi:[1,1]
    v_pk_mul_f32 v[76:77], v[76:77], v[20:21] op_sel:[0,1] op_sel_hi:[1,1]
    v_pk_mul_f32 v[78:79], v[78:79], v[20:21] op_sel:[0,1] op_sel_hi:[1,1]
    v_cvt_f64_f32 v[32:33], v64
    v_cvt_f64_f32 v[34:35], v65
    v_cvt_f64_f32 v[36:37], v66
    v_cvt_f64_f32 v[38:39], v67
    v_cvt_f64_f32 v[40:41], v68
    v_cvt_f64_f32 v[42:43], v69
    v_cvt_f64_f32 v[44:45], v70
    v_cvt_f64_f32 v[46:47], v71
    v_cvt_f64_f32 v[48:49], v72
    v_cvt_f64_f32 v[50:51], v73
    v_cvt_f64_f32 v[52:53], v74
    v_cvt_f64_f32 v[54:55], v75
    v_cvt_f64_f32 v[56:57], v76
    v_cvt_f64_f32 v[58:59], v77
    v_cvt_f64_f32 v[60:61], v78
    v_cvt_f64_f32 v[62:63], v79
    s_cmp_lg_u32 s55, 0
    s_cbranch_scc1 K2_CORRADD
    ds_write_b128 v6, v[32:35] offset:640
    ds_write_b128 v6, v[36:39] offset:656
    ds_write_b128 v6, v[40:43] offset:768
    ds_write_b128 v6, v[44:47] offset:784
    ds_write_b128 v6, v[48:51] offset:896
    ds_write_b128 v6, v[52:55] offset:912
    ds_write_b128 v6, v[56:59] offset:1024
    ds_write_b128 v6, v[60:63] offset:1040
    v_mov_b32 v5, 8
    v_mov_b32 v8, 1
    s_mov_b64 exec, 1
    ds_add_u32 v5, v8
K2_CORRDONE:
    s_mov_b64 exec, -1
    s_waitcnt lgkmcnt(9)
    s_lshl_b32 s3, s46, 5
    v_add_u32 v112, s3, v112
    v_add_u32 v113, s3, v113
    v_add_u32 v114, s3, v114
    v_add_u32 v100, s47, v100
    v_add_u32 v101, s47, v101
    v_add_u32 v102, s47, v102
    v_add_u32 v103, s47, v103
    s_setprio 3
K2_NOCORR:
    s_mov_b32 s49, 0
    s_cmp_eq_u32 s48, 0
    s_cbranch_scc1 K2_DYN0
    ds_read_b32 v124, v112
    ds_read_b32 v125, v113
    ds_read2_b32 v[122:123], v114 offset0:0 offset1:2
    s_waitcnt lgkmcnt(2)
    v_add_u32 v124, v124, v116
    ds_read_u16 v104, v124 offset:0
    ds_read_u16 v106, v124 offset:4
    ds_read_u16 v108, v124 offset:8
    ds_read_u16 v110, v124 offset:12
    ds_read_b32 v124, v112 offset:512
    s_waitcnt lgkmcnt(1)
    s_mov_b32 m0, s47
    s_nop 0
    buffer_load_dwordx4 v[104:105], s[32:35], 0 idxen offen lds
    s_add_u32 m0, s47, 1024
    s_nop 0
    buffer_load_dwordx4 v[106:107], s[32:35], 0 idxen offen lds
    s_add_u32 m0, s47, 2048
    s_nop 0
    buffer_load_dwordx4 v[108:109], s[32:35], 0 idxen offen lds
    s_add_u32 m0, s47, 3072
    s_nop 0
    buffer_load_dwordx4 v[110:111], s[32:35], 0 idxen offen lds
    v_add_u32 v125, v125, v117
    v_add_u32 v118, v122, v115
    v_add_u32 v119, v123, v115
    v_add_u32 v114, 512, v114
    ds_read_u16 v82, v125
    ds_read_b32 v84, v118 offset:27040
    ds_read_b32 v85, v119 offset:27040
    ds_read_b32 v88, v118 offset:27296
    ds_read_b32 v89, v119 offset:27296
    s_waitcnt lgkmcnt(5)
    v_add_u32 v124, v124, v116
    s_cmp_lt_u32 s48, 2
    s_cbranch_scc1 K2_DYN0
    ds_read_u16 v104, v124 offset:0
    ds_read_u16 v106, v124 offset:4
    ds_read_u16 v108, v124 offset:8
    ds_read_u16 v110, v124 offset:12
    ds_read_b32 v124, v112 offset:1024
K2_DYN0:
    s_cmp_eq_u32 s48, 0
    s_cbranch_scc1 K2_LOOPDONE
    s_waitcnt vmcnt(0)
    ds_read_b128 v[64:67], v100
    ds_read_b128 v[68:71], v101
    ds_read_b128 v[72:75], v102
    ds_read_b128 v[76:79], v103
    s_waitcnt lgkmcnt(0)
    v_mov_b32 v5, 8
K2_QPOLL3:
    ds_read_b32 v8, v5
    s_waitcnt lgkmcnt(0)
    v_readfirstlane_b32 s3, v8
    s_cmp_lt_u32 s3, 4
    s_cbranch_scc1 K2_QPOLL3
    s_cmp_lt_u32 s48, 2
    s_cbranch_scc1 K2_DYN1
    s_mov_b32 m0, s47
    s_nop 0
    buffer_load_dwordx4 v[104:105], s[32:35], 0 idxen offen lds
    s_add_u32 m0, s47, 1024
    s_nop 0
    buffer_load_dwordx4 v[106:107], s[32:35], 0 idxen offen lds
    s_add_u32 m0, s47, 2048
    s_nop 0
    buffer_load_dwordx4 v[108:109], s[32:35], 0 idxen offen lds
    s_add_u32 m0, s47, 3072
    s_nop 0
    buffer_load_dwordx4 v[110:111], s[32:35], 0 idxen offen lds
K2_DYN1:
    v_mfma_f32_32x32x16_bf16 v[16:31], v[80:83], v[84:87], 0
    v_mfma_f32_32x32x16_bf16 v[16:31], v[64:67], v[92:95], v[16:31]
    v_mfma_f32_32x32x16_bf16 v[16:31], v[68:71], v[96:99], v[16:31]
    v_add_u32 v124, v124, v116
    s_cmp_lg_u32 s51, 0
    s_nop 7
    s_nop 1
    s_cbranch_scc1 K2_S_LOOP0
K2_F_LOOP0:
    s_sub_u32 s48, s48, 1
    s_cmp_eq_u32 s48, 0
    s_cbranch_scc1 K2_F_TAIL0
    s_add_u32 s49, s49, 1
    s_cmp_lg_u32 s49, 1
    s_cbranch_scc1 K2_F_PR01
    s_setprio 2
K2_F_PR01:
    s_cmp_lg_u32 s49, 2
    s_cbranch_scc1 K2_F_PR02
    s_setprio 1
K2_F_PR02:
    s_cmp_lg_u32 s49, 4
    s_cbranch_scc1 K2_F_PR04
    s_setprio 0
K2_F_PR04:
    ds_read_b32 v125, v113 offset:512
    ds_read2_b32 v[122:123], v114 offset0:0 offset1:2
    s_cmp_lt_u32 s48, 2
    s_cbranch_scc1 K2_F_NOI0
    ds_read_u16 v104, v124 offset:0
    ds_read_u16 v106, v124 offset:4
    ds_read_u16 v108, v124 offset:8
    ds_read_u16 v110, v124 offset:12
    ds_read_b32 v124, v112 offset:1536
K2_F_NOI0:
    v_mfma_f32_32x32x16_bf16 v[32:47], v[80:83], v[88:91], 0
    v_exp_f32 v48, v16
    v_exp_f32 v49, v17
    v_exp_f32 v50, v18
    v_exp_f32 v51, v19
    v_mfma_f32_32x32x16_bf16 v[32:47], v[72:75], v[92:95], v[32:47]
    v_exp_f32 v52, v20
    v_exp_f32 v53, v21
    v_exp_f32 v54, v22
    v_exp_f32 v55, v23
    v_mfma_f32_32x32x16_bf16 v[32:47], v[76:79], v[96:99], v[32:47]
    v_exp_f32 v56, v24
    v_exp_f32 v57, v25
    v_exp_f32 v58, v26
    v_exp_f32 v59, v27
    v_exp_f32 v60, v28
    v_exp_f32 v61, v29
    v_exp_f32 v62, v30
    v_exp_f32 v63, v31
    s_waitcnt vmcnt(0) lgkmcnt(0)
    ds_read_b128 v[64:67], v100
    ds_read_b128 v[68:71], v101
    ds_read_b128 v[72:75], v102
    ds_read_b128 v[76:79], v103
    v_add_u32 v125, v125, v117
    v_add_u32 v120, v122, v115
    v_add_u32 v121, v123, v115
    v_add_u32 v124, v124, v116
    ds_read_u16 v82, v125
    ds_read_b32 v84, v120 offset:27040
    ds_read_b32 v85, v121 offset:27040
    ds_read_b32 v88, v120 offset:27296
    ds_read_b32 v89, v121 offset:27296
    v_pk_add_f32 v[4:5], v[48:49], s[58:59]
    v_pk_fma_f32 v[2:3], v[16:17], v[50:51], v[16:17]
    v_pk_fma_f32 v[6:7], v[4:5], v[50:51], v[4:5]
    v_pk_fma_f32 v[2:3], v[18:19], v[4:5], v[2:3]
    v_pk_fma_f32 v[2:3], v[2:3], v[52:53], v[2:3]
    v_pk_fma_f32 v[4:5], v[6:7], v[52:53], v[6:7]
    v_pk_fma_f32 v[2:3], v[20:21], v[6:7], v[2:3]
    s_cmp_lt_u32 s48, 2
    s_cbranch_scc1 K2_F_NOD0
    s_waitcnt lgkmcnt(5)
    s_mov_b32 m0, s47
    s_nop 0
    buffer_load_dwordx4 v[104:105], s[32:35], 0 idxen offen lds
    s_add_u32 m0, s47, 1024
    s_nop 0
    buffer_load_dwordx4 v[106:107], s[32:35], 0 idxen offen lds
    s_add_u32 m0, s47, 2048
    s_nop 0
    buffer_load_dwordx4 v[108:109], s[32:35], 0 idxen offen lds
    s_add_u32 m0, s47, 3072
    s_nop 0
    buffer_load_dwordx4 v[110:111], s[32:35], 0 idxen offen lds
K2_F_NOD0:
    v_pk_fma_f32 v[2:3], v[2:3], v[54:55], v[2:3]
    v_pk_fma_f32 v[6:7], v[4:5], v[54:55], v[4:5]
    v_pk_fma_f32 v[2:3], v[22:23], v[4:5], v[2:3]
    v_pk_fma_f32 v[2:3], v[2:3], v[56:57], v[2:3]
    v_pk_fma_f32 v[4:5], v[6:7], v[56:57], v[6:7]
    v_pk_fma_f32 v[2:3], v[24:25], v[6:7], v[2:3]
    v_pk_fma_f32 v[2:3], v[2:3], v[58:59], v[2:3]
    v_pk_fma_f32 v[6:7], v[4:5], v[58:59], v[4:5]
    v_pk_fma_f32 v[2:3], v[26:27], v[4:5], v[2:3]
    v_pk_fma_f32 v[2:3], v[2:3], v[60:61], v[2:3]
    v_pk_fma_f32 v[4:5], v[6:7], v[60:61], v[6:7]
    v_pk_fma_f32 v[2:3], v[28:29], v[6:7], v[2:3]
    v_pk_fma_f32 v[2:3], v[2:3], v[62:63], v[2:3]
    v_pk_fma_f32 v[6:7], v[4:5], v[62:63], v[4:5]
    v_pk_fma_f32 v[2:3], v[30:31], v[4:5], v[2:3]
    v_rcp_f32 v8, v6
    v_rcp_f32 v9, v7
    v_max3_f32 v15, v6, v7, v15
    v_pk_mul_f32 v[10:11], v[2:3], v[8:9]
    v_cvt_f64_f32 v[12:13], v11
    v_cvt_f64_f32 v[10:11], v10
    ds_add_f64 v119, v[12:13] offset:640
    ds_add_f64 v118, v[10:11] offset:640
    s_waitcnt lgkmcnt(2)
    v_mfma_f32_32x32x16_bf16 v[16:31], v[80:83], v[84:87], 0
    v_exp_f32 v48, v32
    v_exp_f32 v49, v33
    v_exp_f32 v50, v34
    v_exp_f32 v51, v35
    v_mfma_f32_32x32x16_bf16 v[16:31], v[64:67], v[92:95], v[16:31]
    v_exp_f32 v52, v36
    v_exp_f32 v53, v37
    v_exp_f32 v54, v38
    v_exp_f32 v55, v39
    v_mfma_f32_32x32x16_bf16 v[16:31], v[68:71], v[96:99], v[16:31]
    v_exp_f32 v56, v40
    v_exp_f32 v57, v41
    v_exp_f32 v58, v42
    v_exp_f32 v59, v43
    v_exp_f32 v60, v44
    v_exp_f32 v61, v45
    v_exp_f32 v62, v46
    v_exp_f32 v63, v47
    v_pk_add_f32 v[4:5], v[48:49], s[58:59]
    v_pk_fma_f32 v[2:3], v[32:33], v[50:51], v[32:33]
    v_pk_fma_f32 v[6:7], v[4:5], v[50:51], v[4:5]
    v_pk_fma_f32 v[2:3], v[34:35], v[4:5], v[2:3]
    v_pk_fma_f32 v[2:3], v[2:3], v[52:53], v[2:3]
    v_pk_fma_f32 v[4:5], v[6:7], v[52:53], v[6:7]
    v_pk_fma_f32 v[2:3], v[36:37], v[6:7], v[2:3]
    v_pk_fma_f32 v[2:3], v[2:3], v[54:55], v[2:3]
    v_pk_fma_f32 v[6:7], v[4:5], v[54:55], v[4:5]
    v_pk_fma_f32 v[2:3], v[38:39], v[4:5], v[2:3]
    v_pk_fma_f32 v[2:3], v[2:3], v[56:57], v[2:3]
    v_pk_fma_f32 v[4:5], v[6:7], v[56:57], v[6:7]
    v_pk_fma_f32 v[2:3], v[40:41], v[6:7], v[2:3]
    v_pk_fma_f32 v[2:3], v[2:3], v[58:59], v[2:3]
    v_pk_fma_f32 v[6:7], v[4:5], v[58:59], v[4:5]
    v_pk_fma_f32 v[2:3], v[42:43], v[4:5], v[2:3]
    v_pk_fma_f32 v[2:3], v[2:3], v[60:61], v[2:3]
    v_pk_fma_f32 v[4:5], v[6:7], v[60:61], v[6:7]
    v_pk_fma_f32 v[2:3], v[44:45], v[6:7], v[2:3]
    v_pk_fma_f32 v[2:3], v[2:3], v[62:63], v[2:3]
    v_pk_fma_f32 v[6:7], v[4:5], v[62:63], v[4:5]
    v_pk_fma_f32 v[2:3], v[46:47], v[4:5], v[2:3]
    v_rcp_f32 v8, v6
    v_rcp_f32 v9, v7
    v_max3_f32 v15, v6, v7, v15
    v_pk_mul_f32 v[10:11], v[2:3], v[8:9]
    v_cvt_f64_f32 v[12:13], v11
    v_cvt_f64_f32 v[10:11], v10
    ds_add_f64 v119, v[12:13] offset:896
    ds_add_f64 v118, v[10:11] offset:896
K2_F_LOOP1:
    s_sub_u32 s48, s48, 1
    s_cmp_eq_u32 s48, 0
    s_cbranch_scc1 K2_F_TAIL1
    s_add_u32 s49, s49, 1
    s_cmp_lg_u32 s49, 1
    s_cbranch_scc1 K2_F_PR11
    s_setprio 2
K2_F_PR11:
    s_cmp_lg_u32 s49, 2
    s_cbranch_scc1 K2_F_PR12
    s_setprio 1
K2_F_PR12:
    s_cmp_lg_u32 s49, 4
    s_cbranch_scc1 K2_F_PR14
    s_setprio 0
K2_F_PR14:
    ds_read_b32 v125, v113 offset:1024
    ds_read2_b32 v[122:123], v114 offset0:128 offset1:130
    s_cmp_lt_u32 s48, 2
    s_cbranch_scc1 K2_F_NOI1
    ds_read_u16 v104, v124 offset:0
    ds_read_u16 v106, v124 offset:4
    ds_read_u16 v108, v124 offset:8
    ds_read_u16 v110, v124 offset:12
    ds_read_b32 v124, v112 offset:2048
K2_F_NOI1:
    v_mfma_f32_32x32x16_bf16 v[32:47], v[80:83], v[88:91], 0
    v_exp_f32 v48, v16
    v_exp_f32 v49, v17
    v_exp_f32 v50, v18
    v_exp_f32 v51, v19
    v_mfma_f32_32x32x16_bf16 v[32:47], v[72:75], v[92:95], v[32:47]
    v_exp_f32 v52, v20
    v_exp_f32 v53, v21
    v_exp_f32 v54, v22
    v_exp_f32 v55, v23
    v_mfma_f32_32x32x16_bf16 v[32:47], v[76:79], v[96:99], v[32:47]
    v_exp_f32 v56, v24
    v_exp_f32 v57, v25
    v_exp_f32 v58, v26
    v_exp_f32 v59, v27
    v_exp_f32 v60, v28
    v_exp_f32 v61, v29
    v_exp_f32 v62, v30
    v_exp_f32 v63, v31
    s_waitcnt vmcnt(0) lgkmcnt(0)
    ds_read_b128 v[64:67], v100
    ds_read_b128 v[68:71], v101
    ds_read_b128 v[72:75], v102
    ds_read_b128 v[76:79], v103
    v_add_u32 v125, v125, v117
    v_add_u32 v118, v122, v115
    v_add_u32 v119, v123, v115
    v_add_u32 v124, v124, v116
    ds_read_u16 v82, v125
    ds_read_b32 v84, v118 offset:27040
    ds_read_b32 v85, v119 offset:27040
    ds_read_b32 v88, v118 offset:27296
    ds_read_b32 v89, v119 offset:27296
    v_pk_add_f32 v[4:5], v[48:49], s[58:59]
    v_pk_fma_f32 v[2:3], v[16:17], v[50:51], v[16:17]
    v_pk_fma_f32 v[6:7], v[4:5], v[50:51], v[4:5]
    v_pk_fma_f32 v[2:3], v[18:19], v[4:5], v[2:3]
    v_pk_fma_f32 v[2:3], v[2:3], v[52:53], v[2:3]
    v_pk_fma_f32 v[4:5], v[6:7], v[52:53], v[6:7]
    v_pk_fma_f32 v[2:3], v[20:21], v[6:7], v[2:3]
    s_cmp_lt_u32 s48, 2
    s_cbranch_scc1 K2_F_NOD1
    s_waitcnt lgkmcnt(5)
    s_mov_b32 m0, s47
    s_nop 0
    buffer_load_dwordx4 v[104:105], s[32:35], 0 idxen offen lds
    s_add_u32 m0, s47, 1024
    s_nop 0
    buffer_load_dwordx4 v[106:107], s[32:35], 0 idxen offen lds
    s_add_u32 m0, s47, 2048
    s_nop 0
    buffer_load_dwordx4 v[108:109], s[32:35], 0 idxen offen lds
    s_add_u32 m0, s47, 3072
    s_nop 0
    buffer_load_dwordx4 v[110:111], s[32:35], 0 idxen offen lds
K2_F_NOD1:
    v_pk_fma_f32 v[2:3], v[2:3], v[54:55], v[2:3]
    v_pk_fma_f32 v[6:7], v[4:5], v[54:55], v[4:5]
    v_pk_fma_f32 v[2:3], v[22:23], v[4:5], v[2:3]
    v_pk_fma_f32 v[2:3], v[2:3], v[56:57], v[2:3]
    v_pk_fma_f32 v[4:5], v[6:7], v[56:57], v[6:7]
    v_pk_fma_f32 v[2:3], v[24:25], v[6:7], v[2:3]
    v_pk_fma_f32 v[2:3], v[2:3], v[58:59], v[2:3]
    v_pk_fma_f32 v[6:7], v[4:5], v[58:59], v[4:5]
    v_pk_fma_f32 v[2:3], v[26:27], v[4:5], v[2:3]
    v_pk_fma_f32 v[2:3], v[2:3], v[60:61], v[2:3]
    v_pk_fma_f32 v[4:5], v[6:7], v[60:61], v[6:7]
    v_pk_fma_f32 v[2:3], v[28:29], v[6:7], v[2:3]
    v_pk_fma_f32 v[2:3], v[2:3], v[62:63], v[2:3]
    v_pk_fma_f32 v[6:7], v[4:5], v[62:63], v[4:5]
    v_pk_fma_f32 v[2:3], v[30:31], v[4:5], v[2:3]
    v_rcp_f32 v8, v6
    v_rcp_f32 v9, v7
    v_max3_f32 v15, v6, v7, v15
    v_pk_mul_f32 v[10:11], v[2:3], v[8:9]
    v_cvt_f64_f32 v[12:13], v11
    v_cvt_f64_f32 v[10:11], v10
    ds_add_f64 v121, v[12:13] offset:640
    ds_add_f64 v120, v[10:11] offset:640
    s_waitcnt lgkmcnt(2)
    v_mfma_f32_32x32x16_bf16 v[16:31], v[80:83], v[84:87], 0
    v_exp_f32 v48, v32
    v_exp_f32 v49, v33
    v_exp_f32 v50, v34
    v_exp_f32 v51, v35
    v_mfma_f32_32x32x16_bf16 v[16:31], v[64:67], v[92:95], v[16:31]
    v_exp_f32 v52, v36
    v_exp_f32 v53, v37
    v_exp_f32 v54, v38
    v_exp_f32 v55, v39
    v_mfma_f32_32x32x16_bf16 v[16:31], v[68:71], v[96:99], v[16:31]
    v_exp_f32 v56, v40
    v_exp_f32 v57, v41
    v_exp_f32 v58, v42
    v_exp_f32 v59, v43
    v_exp_f32 v60, v44
    v_exp_f32 v61, v45
    v_exp_f32 v62, v46
    v_exp_f32 v63, v47
    v_add_u32 v112, 1024, v112
    v_add_u32 v113, 1024, v113
    v_add_u32 v114, 1024, v114
    v_pk_add_f32 v[4:5], v[48:49], s[58:59]
    v_pk_fma_f32 v[2:3], v[32:33], v[50:51], v[32:33]
    v_pk_fma_f32 v[6:7], v[4:5], v[50:51], v[4:5]
    v_pk_fma_f32 v[2:3], v[34:35], v[4:5], v[2:3]
    v_pk_fma_f32 v[2:3], v[2:3], v[52:53], v[2:3]
    v_pk_fma_f32 v[4:5], v[6:7], v[52:53], v[6:7]
    v_pk_fma_f32 v[2:3], v[36:37], v[6:7], v[2:3]
    v_pk_fma_f32 v[2:3], v[2:3], v[54:55], v[2:3]
    v_pk_fma_f32 v[6:7], v[4:5], v[54:55], v[4:5]
    v_pk_fma_f32 v[2:3], v[38:39], v[4:5], v[2:3]
    v_pk_fma_f32 v[2:3], v[2:3], v[56:57], v[2:3]
    v_pk_fma_f32 v[4:5], v[6:7], v[56:57], v[6:7]
    v_pk_fma_f32 v[2:3], v[40:41], v[6:7], v[2:3]
    v_pk_fma_f32 v[2:3], v[2:3], v[58:59], v[2:3]
    v_pk_fma_f32 v[6:7], v[4:5], v[58:59], v[4:5]
    v_pk_fma_f32 v[2:3], v[42:43], v[4:5], v[2:3]
    v_pk_fma_f32 v[2:3], v[2:3], v[60:61], v[2:3]
    v_pk_fma_f32 v[4:5], v[6:7], v[60:61], v[6:7]
    v_pk_fma_f32 v[2:3], v[44:45], v[6:7], v[2:3]
    v_pk_fma_f32 v[2:3], v[2:3], v[62:63], v[2:3]
    v_pk_fma_f32 v[6:7], v[4:5], v[62:63], v[4:5]
    v_pk_fma_f32 v[2:3], v[46:47], v[4:5], v[2:3]
    v_rcp_f32 v8, v6
    v_rcp_f32 v9, v7
    v_max3_f32 v15, v6, v7, v15
    v_pk_mul_f32 v[10:11], v[2:3], v[8:9]
    v_cvt_f64_f32 v[12:13], v11
    v_cvt_f64_f32 v[10:11], v10
    ds_add_f64 v121, v[12:13] offset:896
    ds_add_f64 v120, v[10:11] offset:896
    s_branch K2_F_LOOP0
K2_F_TAIL0:
    v_mfma_f32_32x32x16_bf16 v[32:47], v[80:83], v[88:91], 0
    v_exp_f32 v48, v16
    v_exp_f32 v49, v17
    v_exp_f32 v50, v18
    v_exp_f32 v51, v19
    v_mfma_f32_32x32x16_bf16 v[32:47], v[72:75], v[92:95], v[32:47]
    v_exp_f32 v52, v20
    v_exp_f32 v53, v21
    v_exp_f32 v54, v22
    v_exp_f32 v55, v23
    v_mfma_f32_32x32x16_bf16 v[32:47], v[76:79], v[96:99], v[32:47]
    v_exp_f32 v56, v24
    v_exp_f32 v57, v25
    v_exp_f32 v58, v26
    v_exp_f32 v59, v27
    v_exp_f32 v60, v28
    v_exp_f32 v61, v29
    v_exp_f32 v62, v30
    v_exp_f32 v63, v31
    v_pk_add_f32 v[4:5], v[48:49], s[58:59]
    v_pk_fma_f32 v[2:3], v[16:17], v[50:51], v[16:17]
    v_pk_fma_f32 v[6:7], v[4:5], v[50:51], v[4:5]
    v_pk_fma_f32 v[2:3], v[18:19], v[4:5], v[2:3]
    v_pk_fma_f32 v[2:3], v[2:3], v[52:53], v[2:3]
    v_pk_fma_f32 v[4:5], v[6:7], v[52:53], v[6:7]
    v_pk_fma_f32 v[2:3], v[20:21], v[6:7], v[2:3]
    v_pk_fma_f32 v[2:3], v[2:3], v[54:55], v[2:3]
    v_pk_fma_f32 v[6:7], v[4:5], v[54:55], v[4:5]
    v_pk_fma_f32 v[2:3], v[22:23], v[4:5], v[2:3]
    v_pk_fma_f32 v[2:3], v[2:3], v[56:57], v[2:3]
    v_pk_fma_f32 v[4:5], v[6:7], v[56:57], v[6:7]
    v_pk_fma_f32 v[2:3], v[24:25], v[6:7], v[2:3]
    v_pk_fma_f32 v[2:3], v[2:3], v[58:59], v[2:3]
    v_pk_fma_f32 v[6:7], v[4:5], v[58:59], v[4:5]
    v_pk_fma_f32 v[2:3], v[26:27], v[4:5], v[2:3]
    v_pk_fma_f32 v[2:3], v[2:3], v[60:61], v[2:3]
    v_pk_fma_f32 v[4:5], v[6:7], v[60:61], v[6:7]
    v_pk_fma_f32 v[2:3], v[28:29], v[6:7], v[2:3]
    v_pk_fma_f32 v[2:3], v[2:3], v[62:63], v[2:3]
    v_pk_fma_f32 v[6:7], v[4:5], v[62:63], v[4:5]
    v_pk_fma_f32 v[2:3], v[30:31], v[4:5], v[2:3]
    v_rcp_f32 v8, v6
    v_rcp_f32 v9, v7
    v_max3_f32 v15, v6, v7, v15
    v_pk_mul_f32 v[10:11], v[2:3], v[8:9]
    v_cvt_f64_f32 v[12:13], v11
    v_cvt_f64_f32 v[10:11], v10
    ds_add_f64 v119, v[12:13] offset:640
    ds_add_f64 v118, v[10:11] offset:640
    v_exp_f32 v48, v32
    v_exp_f32 v49, v33
    v_exp_f32 v50, v34
    v_exp_f32 v51, v35
    v_exp_f32 v52, v36
    v_exp_f32 v53, v37
    v_exp_f32 v54, v38
    v_exp_f32 v55, v39
    v_exp_f32 v56, v40
    v_exp_f32 v57, v41
    v_exp_f32 v58, v42
    v_exp_f32 v59, v43
    v_exp_f32 v60, v44
    v_exp_f32 v61, v45
    v_exp_f32 v62, v46
    v_exp_f32 v63, v47
    v_pk_add_f32 v[4:5], v[48:49], s[58:59]
    v_pk_fma_f32 v[2:3], v[32:33], v[50:51], v[32:33]
    v_pk_fma_f32 v[6:7], v[4:5], v[50:51], v[4:5]
    v_pk_fma_f32 v[2:3], v[34:35], v[4:5], v[2:3]
    v_pk_fma_f32 v[2:3], v[2:3], v[52:53], v[2:3]
    v_pk_fma_f32 v[4:5], v[6:7], v[52:53], v[6:7]
    v_pk_fma_f32 v[2:3], v[36:37], v[6:7], v[2:3]
    v_pk_fma_f32 v[2:3], v[2:3], v[54:55], v[2:3]
    v_pk_fma_f32 v[6:7], v[4:5], v[54:55], v[4:5]
    v_pk_fma_f32 v[2:3], v[38:39], v[4:5], v[2:3]
    v_pk_fma_f32 v[2:3], v[2:3], v[56:57], v[2:3]
    v_pk_fma_f32 v[4:5], v[6:7], v[56:57], v[6:7]
    v_pk_fma_f32 v[2:3], v[40:41], v[6:7], v[2:3]
    v_pk_fma_f32 v[2:3], v[2:3], v[58:59], v[2:3]
    v_pk_fma_f32 v[6:7], v[4:5], v[58:59], v[4:5]
    v_pk_fma_f32 v[2:3], v[42:43], v[4:5], v[2:3]
    v_pk_fma_f32 v[2:3], v[2:3], v[60:61], v[2:3]
    v_pk_fma_f32 v[4:5], v[6:7], v[60:61], v[6:7]
    v_pk_fma_f32 v[2:3], v[44:45], v[6:7], v[2:3]
    v_pk_fma_f32 v[2:3], v[2:3], v[62:63], v[2:3]
    v_pk_fma_f32 v[6:7], v[4:5], v[62:63], v[4:5]
    v_pk_fma_f32 v[2:3], v[46:47], v[4:5], v[2:3]
    v_rcp_f32 v8, v6
    v_rcp_f32 v9, v7
    v_max3_f32 v15, v6, v7, v15
    v_pk_mul_f32 v[10:11], v[2:3], v[8:9]
    v_cvt_f64_f32 v[12:13], v11
    v_cvt_f64_f32 v[10:11], v10
    ds_add_f64 v119, v[12:13] offset:896
    ds_add_f64 v118, v[10:11] offset:896
    s_branch K2_LOOPDONE
K2_F_TAIL1:
    v_mfma_f32_32x32x16_bf16 v[32:47], v[80:83], v[88:91], 0
    v_exp_f32 v48, v16
    v_exp_f32 v49, v17
    v_exp_f32 v50, v18
    v_exp_f32 v51, v19
    v_mfma_f32_32x32x16_bf16 v[32:47], v[72:75], v[92:95], v[32:47]
    v_exp_f32 v52, v20
    v_exp_f32 v53, v21
    v_exp_f32 v54, v22
    v_exp_f32 v55, v23
    v_mfma_f32_32x32x16_bf16 v[32:47], v[76:79], v[96:99], v[32:47]
    v_exp_f32 v56, v24
    v_exp_f32 v57, v25
    v_exp_f32 v58, v26
    v_exp_f32 v59, v27
    v_exp_f32 v60, v28
    v_exp_f32 v61, v29
    v_exp_f32 v62, v30
    v_exp_f32 v63, v31
    v_pk_add_f32 v[4:5], v[48:49], s[58:59]
    v_pk_fma_f32 v[2:3], v[16:17], v[50:51], v[16:17]
    v_pk_fma_f32 v[6:7], v[4:5], v[50:51], v[4:5]
    v_pk_fma_f32 v[2:3], v[18:19], v[4:5], v[2:3]
    v_pk_fma_f32 v[2:3], v[2:3], v[52:53], v[2:3]
    v_pk_fma_f32 v[4:5], v[6:7], v[52:53], v[6:7]
    v_pk_fma_f32 v[2:3], v[20:21], v[6:7], v[2:3]
    v_pk_fma_f32 v[2:3], v[2:3], v[54:55], v[2:3]
    v_pk_fma_f32 v[6:7], v[4:5], v[54:55], v[4:5]
    v_pk_fma_f32 v[2:3], v[22:23], v[4:5], v[2:3]
    v_pk_fma_f32 v[2:3], v[2:3], v[56:57], v[2:3]
    v_pk_fma_f32 v[4:5], v[6:7], v[56:57], v[6:7]
    v_pk_fma_f32 v[2:3], v[24:25], v[6:7], v[2:3]
    v_pk_fma_f32 v[2:3], v[2:3], v[58:59], v[2:3]
    v_pk_fma_f32 v[6:7], v[4:5], v[58:59], v[4:5]
    v_pk_fma_f32 v[2:3], v[26:27], v[4:5], v[2:3]
    v_pk_fma_f32 v[2:3], v[2:3], v[60:61], v[2:3]
    v_pk_fma_f32 v[4:5], v[6:7], v[60:61], v[6:7]
    v_pk_fma_f32 v[2:3], v[28:29], v[6:7], v[2:3]
    v_pk_fma_f32 v[2:3], v[2:3], v[62:63], v[2:3]
    v_pk_fma_f32 v[6:7], v[4:5], v[62:63], v[4:5]
    v_pk_fma_f32 v[2:3], v[30:31], v[4:5], v[2:3]
    v_rcp_f32 v8, v6
    v_rcp_f32 v9, v7
    v_max3_f32 v15, v6, v7, v15
    v_pk_mul_f32 v[10:11], v[2:3], v[8:9]
    v_cvt_f64_f32 v[12:13], v11
    v_cvt_f64_f32 v[10:11], v10
    ds_add_f64 v121, v[12:13] offset:640
    ds_add_f64 v120, v[10:11] offset:640
    v_exp_f32 v48, v32
    v_exp_f32 v49, v33
    v_exp_f32 v50, v34
    v_exp_f32 v51, v35
    v_exp_f32 v52, v36
    v_exp_f32 v53, v37
    v_exp_f32 v54, v38
    v_exp_f32 v55, v39
    v_exp_f32 v56, v40
    v_exp_f32 v57, v41
    v_exp_f32 v58, v42
    v_exp_f32 v59, v43
    v_exp_f32 v60, v44
    v_exp_f32 v61, v45
    v_exp_f32 v62, v46
    v_exp_f32 v63, v47
    v_pk_add_f32 v[4:5], v[48:49], s[58:59]
    v_pk_fma_f32 v[2:3], v[32:33], v[50:51], v[32:33]
    v_pk_fma_f32 v[6:7], v[4:5], v[50:51], v[4:5]
    v_pk_fma_f32 v[2:3], v[34:35], v[4:5], v[2:3]
    v_pk_fma_f32 v[2:3], v[2:3], v[52:53], v[2:3]
    v_pk_fma_f32 v[4:5], v[6:7], v[52:53], v[6:7]
    v_pk_fma_f32 v[2:3], v[36:37], v[6:7], v[2:3]
    v_pk_fma_f32 v[2:3], v[2:3], v[54:55], v[2:3]
    v_pk_fma_f32 v[6:7], v[4:5], v[54:55], v[4:5]
    v_pk_fma_f32 v[2:3], v[38:39], v[4:5], v[2:3]
    v_pk_fma_f32 v[2:3], v[2:3], v[56:57], v[2:3]
    v_pk_fma_f32 v[4:5], v[6:7], v[56:57], v[6:7]
    v_pk_fma_f32 v[2:3], v[40:41], v[6:7], v[2:3]
    v_pk_fma_f32 v[2:3], v[2:3], v[58:59], v[2:3]
    v_pk_fma_f32 v[6:7], v[4:5], v[58:59], v[4:5]
    v_pk_fma_f32 v[2:3], v[42:43], v[4:5], v[2:3]
    v_pk_fma_f32 v[2:3], v[2:3], v[60:61], v[2:3]
    v_pk_fma_f32 v[4:5], v[6:7], v[60:61], v[6:7]
    v_pk_fma_f32 v[2:3], v[44:45], v[6:7], v[2:3]
    v_pk_fma_f32 v[2:3], v[2:3], v[62:63], v[2:3]
    v_pk_fma_f32 v[6:7], v[4:5], v[62:63], v[4:5]
    v_pk_fma_f32 v[2:3], v[46:47], v[4:5], v[2:3]
    v_rcp_f32 v8, v6
    v_rcp_f32 v9, v7
    v_max3_f32 v15, v6, v7, v15
    v_pk_mul_f32 v[10:11], v[2:3], v[8:9]
    v_cvt_f64_f32 v[12:13], v11
    v_cvt_f64_f32 v[10:11], v10
    ds_add_f64 v121, v[12:13] offset:896
    ds_add_f64 v120, v[10:11] offset:896
    s_branch K2_LOOPDONE
K2_LOOPDONE:
    v_mov_b32 v2, 0x76800000
    v_mov_b32 v3, 0x5f800000
    v_cmp_nlt_f32 vcc, v126, v2
    v_cmp_nlt_f32 s[84:85], v15, v3
    s_or_b64 vcc, vcc, s[84:85]
    s_cbranch_scc0 K2_AFTER
    v_mov_b32 v3, 628
    v_mov_b32 v2, 1
    ds_write_b32 v3, v2
K2_AFTER:
    v_mov_b32 v3, 624
    s_cmp_eq_u32 s27, 0
    s_cbranch_scc1 K2_B4
    v_lshrrev_b32 v7, 4, v1
    s_lshl_b32 s3, s53, 4
    v_and_b32 v9, 15, v1
    v_add_u32 v9, s3, v9
    v_add_u32 v6, s45, v9
    v_lshlrev_b32 v6, 7, v6
    v_lshl_add_u32 v4, v7, 4, v6
    buffer_load_dwordx4 v[16:19], v4, s[16:19], 0 offen
    buffer_load_dwordx4 v[20:23], v4, s[16:19], 0 offen offset:64
    v_lshlrev_b32 v4, 4, v1
    s_mov_b32 s3, 16384
    buffer_load_dwordx4 v[96:99], v4, s[8:11], s3 offen offset:0
    buffer_load_dwordx4 v[100:103], v4, s[8:11], s3 offen offset:1024
    buffer_load_dwordx4 v[104:107], v4, s[8:11], s3 offen offset:2048
    buffer_load_dwordx4 v[108:111], v4, s[8:11], s3 offen offset:3072
    s_mov_b32 s3, 20480
    buffer_load_dwordx4 v[32:35], v4, s[8:11], s3 offen offset:0
    buffer_load_dwordx4 v[36:39], v4, s[8:11], s3 offen offset:1024
    buffer_load_dwordx4 v[40:43], v4, s[8:11], s3 offen offset:2048
    buffer_load_dwordx4 v[44:47], v4, s[8:11], s3 offen offset:3072
    s_mov_b32 s3, 24576
    buffer_load_dwordx4 v[48:51], v4, s[8:11], s3 offen offset:0
    buffer_load_dwordx4 v[52:55], v4, s[8:11], s3 offen offset:1024
    buffer_load_dwordx4 v[56:59], v4, s[8:11], s3 offen offset:2048
    buffer_load_dwordx4 v[60:63], v4, s[8:11], s3 offen offset:3072
    s_mov_b32 s3, 28672
    buffer_load_dwordx4 v[64:67], v4, s[8:11], s3 offen offset:0
    buffer_load_dwordx4 v[68:71], v4, s[8:11], s3 offen offset:1024
    buffer_load_dwordx4 v[72:75], v4, s[8:11], s3 offen offset:2048
    buffer_load_dwordx4 v[76:79], v4, s[8:11], s3 offen offset:3072
    v_mul_u32_u24 v8, 528, v9
    v_lshl_add_u32 v8, v7, 6, v8
    v_lshl_add_u32 v6, v7, 5, v6
    s_mov_b32 s86, 0xbfb8aa3b
    s_mov_b32 s87, 0xbfb8aa3b
    s_waitcnt vmcnt(8)
    v_mfma_f32_16x16x32_bf16 v[80:83], v[96:99], v[16:19], 0
    v_mfma_f32_16x16x32_bf16 v[84:87], v[104:107], v[16:19], 0
    v_mfma_f32_16x16x32_bf16 v[88:91], v[32:35], v[16:19], 0
    v_mfma_f32_16x16x32_bf16 v[92:95], v[40:43], v[16:19], 0
    v_mfma_f32_16x16x32_bf16 v[80:83], v[100:103], v[20:23], v[80:83]
    v_mfma_f32_16x16x32_bf16 v[84:87], v[108:111], v[20:23], v[84:87]
    v_mfma_f32_16x16x32_bf16 v[88:91], v[36:39], v[20:23], v[88:91]
    v_mfma_f32_16x16x32_bf16 v[92:95], v[44:47], v[20:23], v[92:95]
    s_nop 4
    v_pk_mul_f32 v[80:81], v[80:81], s[86:87]
    v_pk_mul_f32 v[82:83], v[82:83], s[86:87]
    v_pk_mul_f32 v[84:85], v[84:85], s[86:87]
    v_pk_mul_f32 v[86:87], v[86:87], s[86:87]
    v_pk_mul_f32 v[88:89], v[88:89], s[86:87]
    v_pk_mul_f32 v[90:91], v[90:91], s[86:87]
    s_nop 0
    v_pk_mul_f32 v[92:93], v[92:93], s[86:87]
    v_pk_mul_f32 v[94:95], v[94:95], s[86:87]
    s_waitcnt vmcnt(0)
K2_B4:
    s_waitcnt lgkmcnt(0)
    s_barrier
    ds_read_b64 v[12:13], v3
    s_cmp_eq_u32 s27, 0
    s_cbranch_scc1 K2_NOAGG
    ds_read_b128 v[16:19], v8 offset:640
    ds_read_b128 v[20:23], v8 offset:656
    ds_read_b128 v[24:27], v8 offset:672
    ds_read_b128 v[28:31], v8 offset:688
    ds_read_b128 v[32:35], v8 offset:896
    ds_read_b128 v[36:39], v8 offset:912
    ds_read_b128 v[40:43], v8 offset:928
    ds_read_b128 v[44:47], v8 offset:944
    s_mov_b32 s86, 0xbfb8aa3b
    s_mov_b32 s87, 0xbfb8aa3b
    s_mov_b32 s4, 0xbf317218
    s_mov_b32 s5, 0xbf317218
    s_waitcnt lgkmcnt(7)
    v_cvt_f32_f64 v96, v[16:17]
    v_cvt_f32_f64 v97, v[18:19]
    v_pk_mul_f32 v[96:97], v[96:97], s[4:5]
    v_cvt_pk_bf16_f32 v112, v96, v97
    s_waitcnt lgkmcnt(6)
    v_cvt_f32_f64 v98, v[20:21]
    v_cvt_f32_f64 v99, v[22:23]
    v_pk_mul_f32 v[98:99], v[98:99], s[4:5]
    v_cvt_pk_bf16_f32 v113, v98, v99
    s_waitcnt lgkmcnt(5)
    v_cvt_f32_f64 v100, v[24:25]
    v_cvt_f32_f64 v101, v[26:27]
    v_pk_mul_f32 v[100:101], v[100:101], s[4:5]
    v_cvt_pk_bf16_f32 v114, v100, v101
    s_waitcnt lgkmcnt(4)
    v_cvt_f32_f64 v102, v[28:29]
    v_cvt_f32_f64 v103, v[30:31]
    v_pk_mul_f32 v[102:103], v[102:103], s[4:5]
    v_cvt_pk_bf16_f32 v115, v102, v103
    s_waitcnt lgkmcnt(3)
    v_cvt_f32_f64 v104, v[32:33]
    v_cvt_f32_f64 v105, v[34:35]
    v_pk_mul_f32 v[104:105], v[104:105], s[4:5]
    v_cvt_pk_bf16_f32 v116, v104, v105
    s_waitcnt lgkmcnt(2)
    v_cvt_f32_f64 v106, v[36:37]
    v_cvt_f32_f64 v107, v[38:39]
    v_pk_mul_f32 v[106:107], v[106:107], s[4:5]
    v_cvt_pk_bf16_f32 v117, v106, v107
    s_waitcnt lgkmcnt(1)
    v_cvt_f32_f64 v108, v[40:41]
    v_cvt_f32_f64 v109, v[42:43]
    v_pk_mul_f32 v[108:109], v[108:109], s[4:5]
    v_cvt_pk_bf16_f32 v118, v108, v109
    s_waitcnt lgkmcnt(0)
    v_cvt_f32_f64 v110, v[44:45]
    v_cvt_f32_f64 v111, v[46:47]
    v_pk_mul_f32 v[110:111], v[110:111], s[4:5]
    v_cvt_pk_bf16_f32 v119, v110, v111
    s_branch K2_FL
K2_NOAGG:
    s_waitcnt lgkmcnt(0)
K2_FL:
    v_readfirstlane_b32 s84, v12
    v_readfirstlane_b32 s85, v13
    s_cmp_lg_u32 s52, 0
    s_cbranch_scc1 K2_RETRY
    s_add_u32 s3, s50, 36
    s_cmp_gt_u32 s84, s3
    s_cbranch_scc1 K2_NEXTCHUNK
    s_andn2_b32 s85, s85, s51
    s_cbranch_scc1 K2_GOSLOW
    s_cmp_eq_u32 s27, 0
    s_cbranch_scc1 K2_FIN
    v_cmp_gt_u32 vcc, 49, v9
    v_mov_b32 v12, s86
    v_mov_b32 v13, s86
    v_mfma_f32_16x16x32_bf16 v[16:19], v[48:51], v[112:115], 0
    v_mfma_f32_16x16x32_bf16 v[20:23], v[56:59], v[112:115], 0
    v_mfma_f32_16x16x32_bf16 v[24:27], v[64:67], v[112:115], 0
    v_mfma_f32_16x16x32_bf16 v[28:31], v[72:75], v[112:115], 0
    v_mfma_f32_16x16x32_bf16 v[16:19], v[52:55], v[116:119], v[16:19]
    v_mfma_f32_16x16x32_bf16 v[20:23], v[60:63], v[116:119], v[20:23]
    v_mfma_f32_16x16x32_bf16 v[24:27], v[68:71], v[116:119], v[24:27]
    v_mfma_f32_16x16x32_bf16 v[28:31], v[76:79], v[116:119], v[28:31]
    s_nop 4
    v_pk_fma_f32 v[80:81], v[16:17], s[86:87], v[80:81]
    v_pk_fma_f32 v[82:83], v[18:19], s[86:87], v[82:83]
    v_pk_fma_f32 v[84:85], v[20:21], s[86:87], v[84:85]
    v_pk_fma_f32 v[86:87], v[22:23], s[86:87], v[86:87]
    v_pk_fma_f32 v[88:89], v[24:25], s[86:87], v[88:89]
    v_pk_fma_f32 v[90:91], v[26:27], s[86:87], v[90:91]
    s_nop 0
    v_pk_fma_f32 v[92:93], v[28:29], s[86:87], v[92:93]
    v_pk_fma_f32 v[94:95], v[30:31], s[86:87], v[94:95]
    v_exp_f32 v16, v80
    v_exp_f32 v17, v81
    v_exp_f32 v18, v82
    v_exp_f32 v19, v83
    v_exp_f32 v20, v84
    v_exp_f32 v21, v85
    v_exp_f32 v22, v86
    v_exp_f32 v23, v87
    v_exp_f32 v24, v88
    v_exp_f32 v25, v89
    v_exp_f32 v26, v90
    v_exp_f32 v27, v91
    v_exp_f32 v28, v92
    v_exp_f32 v29, v93
    v_exp_f32 v30, v94
    v_exp_f32 v31, v95
    v_pk_fma_f32 v[16:17], v[16:17], s[86:87], v[12:13]
    v_pk_fma_f32 v[18:19], v[18:19], s[86:87], v[12:13]
    v_pk_fma_f32 v[20:21], v[20:21], s[86:87], v[12:13]
    v_pk_fma_f32 v[22:23], v[22:23], s[86:87], v[12:13]
    v_pk_fma_f32 v[24:25], v[24:25], s[86:87], v[12:13]
    v_pk_fma_f32 v[26:27], v[26:27], s[86:87], v[12:13]
    v_pk_fma_f32 v[28:29], v[28:29], s[86:87], v[12:13]
    v_pk_fma_f32 v[30:31], v[30:31], s[86:87], v[12:13]
    v_rcp_f32 v16, v16
    v_rcp_f32 v17, v17
    v_rcp_f32 v18, v18
    v_rcp_f32 v19, v19
    v_rcp_f32 v20, v20
    v_rcp_f32 v21, v21
    v_rcp_f32 v22, v22
    v_rcp_f32 v23, v23
    v_rcp_f32 v24, v24
    v_rcp_f32 v25, v25
    v_rcp_f32 v26, v26
    v_rcp_f32 v27, v27
    v_rcp_f32 v28, v28
    v_rcp_f32 v29, v29
    v_rcp_f32 v30, v30
    v_rcp_f32 v31, v31
    v_pk_mul_f32 v[16:17], v[16:17], v[80:81]
    v_pk_mul_f32 v[18:19], v[18:19], v[82:83]
    v_pk_mul_f32 v[20:21], v[20:21], v[84:85]
    v_pk_mul_f32 v[22:23], v[22:23], v[86:87]
    v_pk_mul_f32 v[24:25], v[24:25], v[88:89]
    v_pk_mul_f32 v[26:27], v[26:27], v[90:91]
    v_pk_mul_f32 v[28:29], v[28:29], v[92:93]
    v_pk_mul_f32 v[30:31], v[30:31], v[94:95]
    v_cvt_pk_bf16_f32 v32, v16, v17
    v_cvt_pk_bf16_f32 v33, v18, v19
    v_cvt_pk_bf16_f32 v34, v20, v21
    v_cvt_pk_bf16_f32 v35, v22, v23
    v_cvt_pk_bf16_f32 v36, v24, v25
    v_cvt_pk_bf16_f32 v37, v26, v27
    v_cvt_pk_bf16_f32 v38, v28, v29
    v_cvt_pk_bf16_f32 v39, v30, v31
    s_mov_b64 exec, vcc
    buffer_store_dwordx4 v[32:35], v6, s[28:31], 0 offen
    buffer_store_dwordx4 v[36:39], v6, s[28:31], 0 offen offset:16
K2_FIN:
K2_END:
    s_endpgm
K2_S_LOOP0:
    s_sub_u32 s48, s48, 1
    s_cmp_eq_u32 s48, 0
    s_cbranch_scc1 K2_S_TAIL0
    ds_read_b32 v125, v113 offset:512
    ds_read2_b32 v[122:123], v114 offset0:0 offset1:2
    s_cmp_lt_u32 s48, 2
    s_cbranch_scc1 K2_S_NOI0
    ds_read_u16 v104, v124 offset:0
    ds_read_u16 v106, v124 offset:4
    ds_read_u16 v108, v124 offset:8
    ds_read_u16 v110, v124 offset:12
    ds_read_b32 v124, v112 offset:1536
K2_S_NOI0:
    v_mfma_f32_32x32x16_bf16 v[32:47], v[80:83], v[88:91], 0
    v_exp_f32 v48, v16
    v_exp_f32 v49, v17
    v_exp_f32 v50, v18
    v_exp_f32 v51, v19
    v_mfma_f32_32x32x16_bf16 v[32:47], v[72:75], v[92:95], v[32:47]
    v_exp_f32 v52, v20
    v_exp_f32 v53, v21
    v_exp_f32 v54, v22
    v_exp_f32 v55, v23
    v_mfma_f32_32x32x16_bf16 v[32:47], v[76:79], v[96:99], v[32:47]
    v_exp_f32 v56, v24
    v_exp_f32 v57, v25
    v_exp_f32 v58, v26
    v_exp_f32 v59, v27
    v_exp_f32 v60, v28
    v_exp_f32 v61, v29
    v_exp_f32 v62, v30
    v_exp_f32 v63, v31
    s_waitcnt vmcnt(0) lgkmcnt(0)
    ds_read_b128 v[64:67], v100
    ds_read_b128 v[68:71], v101
    ds_read_b128 v[72:75], v102
    ds_read_b128 v[76:79], v103
    v_add_u32 v125, v125, v117
    v_add_u32 v120, v122, v115
    v_add_u32 v121, v123, v115
    v_add_u32 v124, v124, v116
    ds_read_u16 v82, v125
    ds_read_b32 v84, v120 offset:27040
    ds_read_b32 v85, v121 offset:27040
    ds_read_b32 v88, v120 offset:27296
    ds_read_b32 v89, v121 offset:27296
    v_pk_add_f32 v[48:49], v[48:49], s[58:59]
    v_pk_add_f32 v[50:51], v[50:51], s[58:59]
    v_pk_add_f32 v[52:53], v[52:53], s[58:59]
    v_pk_add_f32 v[54:55], v[54:55], s[58:59]
    v_pk_add_f32 v[56:57], v[56:57], s[58:59]
    v_pk_add_f32 v[58:59], v[58:59], s[58:59]
    v_pk_add_f32 v[60:61], v[60:61], s[58:59]
    v_pk_add_f32 v[62:63], v[62:63], s[58:59]
    s_cmp_lt_u32 s48, 2
    s_cbranch_scc1 K2_S_NOD0
    s_waitcnt lgkmcnt(5)
    s_mov_b32 m0, s47
    s_nop 0
    buffer_load_dwordx4 v[104:105], s[32:35], 0 idxen offen lds
    s_add_u32 m0, s47, 1024
    s_nop 0
    buffer_load_dwordx4 v[106:107], s[32:35], 0 idxen offen lds
    s_add_u32 m0, s47, 2048
    s_nop 0
    buffer_load_dwordx4 v[108:109], s[32:35], 0 idxen offen lds
    s_add_u32 m0, s47, 3072
    s_nop 0
    buffer_load_dwordx4 v[110:111], s[32:35], 0 idxen offen lds
K2_S_NOD0:
    v_rcp_f32 v48, v48
    v_rcp_f32 v49, v49
    v_rcp_f32 v50, v50
    v_rcp_f32 v51, v51
    v_rcp_f32 v52, v52
    v_rcp_f32 v53, v53
    v_rcp_f32 v54, v54
    v_rcp_f32 v55, v55
    v_rcp_f32 v56, v56
    v_rcp_f32 v57, v57
    v_rcp_f32 v58, v58
    v_rcp_f32 v59, v59
    v_rcp_f32 v60, v60
    v_rcp_f32 v61, v61
    v_rcp_f32 v62, v62
    v_rcp_f32 v63, v63
    s_nop 0
    v_pk_mul_f32 v[10:11], v[16:17], v[48:49]
    v_pk_fma_f32 v[10:11], v[18:19], v[50:51], v[10:11]
    v_pk_fma_f32 v[10:11], v[20:21], v[52:53], v[10:11]
    v_pk_fma_f32 v[10:11], v[22:23], v[54:55], v[10:11]
    v_pk_fma_f32 v[10:11], v[24:25], v[56:57], v[10:11]
    v_pk_fma_f32 v[10:11], v[26:27], v[58:59], v[10:11]
    v_pk_fma_f32 v[10:11], v[28:29], v[60:61], v[10:11]
    v_pk_fma_f32 v[10:11], v[30:31], v[62:63], v[10:11]
    v_cvt_f64_f32 v[12:13], v11
    v_cvt_f64_f32 v[10:11], v10
    ds_add_f64 v119, v[12:13] offset:640
    ds_add_f64 v118, v[10:11] offset:640
    s_waitcnt lgkmcnt(2)
    v_mfma_f32_32x32x16_bf16 v[16:31], v[80:83], v[84:87], 0
    v_exp_f32 v48, v32
    v_exp_f32 v49, v33
    v_exp_f32 v50, v34
    v_exp_f32 v51, v35
    v_mfma_f32_32x32x16_bf16 v[16:31], v[64:67], v[92:95], v[16:31]
    v_exp_f32 v52, v36
    v_exp_f32 v53, v37
    v_exp_f32 v54, v38
    v_exp_f32 v55, v39
    v_mfma_f32_32x32x16_bf16 v[16:31], v[68:71], v[96:99], v[16:31]
    v_exp_f32 v56, v40
    v_exp_f32 v57, v41
    v_exp_f32 v58, v42
    v_exp_f32 v59, v43
    v_exp_f32 v60, v44
    v_exp_f32 v61, v45
    v_exp_f32 v62, v46
    v_exp_f32 v63, v47
    v_pk_add_f32 v[48:49], v[48:49], s[58:59]
    v_pk_add_f32 v[50:51], v[50:51], s[58:59]
    v_pk_add_f32 v[52:53], v[52:53], s[58:59]
    v_pk_add_f32 v[54:55], v[54:55], s[58:59]
    v_pk_add_f32 v[56:57], v[56:57], s[58:59]
    v_pk_add_f32 v[58:59], v[58:59], s[58:59]
    v_pk_add_f32 v[60:61], v[60:61], s[58:59]
    v_pk_add_f32 v[62:63], v[62:63], s[58:59]
    v_rcp_f32 v48, v48
    v_rcp_f32 v49, v49
    v_rcp_f32 v50, v50
    v_rcp_f32 v51, v51
    v_rcp_f32 v52, v52
    v_rcp_f32 v53, v53
    v_rcp_f32 v54, v54
    v_rcp_f32 v55, v55
    v_rcp_f32 v56, v56
    v_rcp_f32 v57, v57
    v_rcp_f32 v58, v58
    v_rcp_f32 v59, v59
    v_rcp_f32 v60, v60
    v_rcp_f32 v61, v61
    v_rcp_f32 v62, v62
    v_rcp_f32 v63, v63
    s_nop 0
    v_pk_mul_f32 v[10:11], v[32:33], v[48:49]
    v_pk_fma_f32 v[10:11], v[34:35], v[50:51], v[10:11]
    v_pk_fma_f32 v[10:11], v[36:37], v[52:53], v[10:11]
    v_pk_fma_f32 v[10:11], v[38:39], v[54:55], v[10:11]
    v_pk_fma_f32 v[10:11], v[40:41], v[56:57], v[10:11]
    v_pk_fma_f32 v[10:11], v[42:43], v[58:59], v[10:11]
    v_pk_fma_f32 v[10:11], v[44:45], v[60:61], v[10:11]
    v_pk_fma_f32 v[10:11], v[46:47], v[62:63], v[10:11]
    v_cvt_f64_f32 v[12:13], v11
    v_cvt_f64_f32 v[10:11], v10
    ds_add_f64 v119, v[12:13] offset:896
    ds_add_f64 v118, v[10:11] offset:896
K2_S_LOOP1:
    s_sub_u32 s48, s48, 1
    s_cmp_eq_u32 s48, 0
    s_cbranch_scc1 K2_S_TAIL1
    ds_read_b32 v125, v113 offset:1024
    ds_read2_b32 v[122:123], v114 offset0:128 offset1:130
    s_cmp_lt_u32 s48, 2
    s_cbranch_scc1 K2_S_NOI1
    ds_read_u16 v104, v124 offset:0
    ds_read_u16 v106, v124 offset:4
    ds_read_u16 v108, v124 offset:8
    ds_read_u16 v110, v124 offset:12
    ds_read_b32 v124, v112 offset:2048
K2_S_NOI1:
    v_mfma_f32_32x32x16_bf16 v[32:47], v[80:83], v[88:91], 0
    v_exp_f32 v48, v16
    v_exp_f32 v49, v17
    v_exp_f32 v50, v18
    v_exp_f32 v51, v19
    v_mfma_f32_32x32x16_bf16 v[32:47], v[72:75], v[92:95], v[32:47]
    v_exp_f32 v52, v20
    v_exp_f32 v53, v21
    v_exp_f32 v54, v22
    v_exp_f32 v55, v23
    v_mfma_f32_32x32x16_bf16 v[32:47], v[76:79], v[96:99], v[32:47]
    v_exp_f32 v56, v24
    v_exp_f32 v57, v25
    v_exp_f32 v58, v26
    v_exp_f32 v59, v27
    v_exp_f32 v60, v28
    v_exp_f32 v61, v29
    v_exp_f32 v62, v30
    v_exp_f32 v63, v31
    s_waitcnt vmcnt(0) lgkmcnt(0)
    ds_read_b128 v[64:67], v100
    ds_read_b128 v[68:71], v101
    ds_read_b128 v[72:75], v102
    ds_read_b128 v[76:79], v103
    v_add_u32 v125, v125, v117
    v_add_u32 v118, v122, v115
    v_add_u32 v119, v123, v115
    v_add_u32 v124, v124, v116
    ds_read_u16 v82, v125
    ds_read_b32 v84, v118 offset:27040
    ds_read_b32 v85, v119 offset:27040
    ds_read_b32 v88, v118 offset:27296
    ds_read_b32 v89, v119 offset:27296
    v_pk_add_f32 v[48:49], v[48:49], s[58:59]
    v_pk_add_f32 v[50:51], v[50:51], s[58:59]
    v_pk_add_f32 v[52:53], v[52:53], s[58:59]
    v_pk_add_f32 v[54:55], v[54:55], s[58:59]
    v_pk_add_f32 v[56:57], v[56:57], s[58:59]
    v_pk_add_f32 v[58:59], v[58:59], s[58:59]
    v_pk_add_f32 v[60:61], v[60:61], s[58:59]
    v_pk_add_f32 v[62:63], v[62:63], s[58:59]
    s_cmp_lt_u32 s48, 2
    s_cbranch_scc1 K2_S_NOD1
    s_waitcnt lgkmcnt(5)
    s_mov_b32 m0, s47
    s_nop 0
    buffer_load_dwordx4 v[104:105], s[32:35], 0 idxen offen lds
    s_add_u32 m0, s47, 1024
    s_nop 0
    buffer_load_dwordx4 v[106:107], s[32:35], 0 idxen offen lds
    s_add_u32 m0, s47, 2048
    s_nop 0
    buffer_load_dwordx4 v[108:109], s[32:35], 0 idxen offen lds
    s_add_u32 m0, s47, 3072
    s_nop 0
    buffer_load_dwordx4 v[110:111], s[32:35], 0 idxen offen lds
K2_S_NOD1:
    v_rcp_f32 v48, v48
    v_rcp_f32 v49, v49
    v_rcp_f32 v50, v50
    v_rcp_f32 v51, v51
    v_rcp_f32 v52, v52
    v_rcp_f32 v53, v53
    v_rcp_f32 v54, v54
    v_rcp_f32 v55, v55
    v_rcp_f32 v56, v56
    v_rcp_f32 v57, v57
    v_rcp_f32 v58, v58
    v_rcp_f32 v59, v59
    v_rcp_f32 v60, v60
    v_rcp_f32 v61, v61
    v_rcp_f32 v62, v62
    v_rcp_f32 v63, v63
    s_nop 0
    v_pk_mul_f32 v[10:11], v[16:17], v[48:49]
    v_pk_fma_f32 v[10:11], v[18:19], v[50:51], v[10:11]
    v_pk_fma_f32 v[10:11], v[20:21], v[52:53], v[10:11]
    v_pk_fma_f32 v[10:11], v[22:23], v[54:55], v[10:11]
    v_pk_fma_f32 v[10:11], v[24:25], v[56:57], v[10:11]
    v_pk_fma_f32 v[10:11], v[26:27], v[58:59], v[10:11]
    v_pk_fma_f32 v[10:11], v[28:29], v[60:61], v[10:11]
    v_pk_fma_f32 v[10:11], v[30:31], v[62:63], v[10:11]
    v_cvt_f64_f32 v[12:13], v11
    v_cvt_f64_f32 v[10:11], v10
    ds_add_f64 v121, v[12:13] offset:640
    ds_add_f64 v120, v[10:11] offset:640
    s_waitcnt lgkmcnt(2)
    v_mfma_f32_32x32x16_bf16 v[16:31], v[80:83], v[84:87], 0
    v_exp_f32 v48, v32
    v_exp_f32 v49, v33
    v_exp_f32 v50, v34
    v_exp_f32 v51, v35
    v_mfma_f32_32x32x16_bf16 v[16:31], v[64:67], v[92:95], v[16:31]
    v_exp_f32 v52, v36
    v_exp_f32 v53, v37
    v_exp_f32 v54, v38
    v_exp_f32 v55, v39
    v_mfma_f32_32x32x16_bf16 v[16:31], v[68:71], v[96:99], v[16:31]
    v_exp_f32 v56, v40
    v_exp_f32 v57, v41
    v_exp_f32 v58, v42
    v_exp_f32 v59, v43
    v_exp_f32 v60, v44
    v_exp_f32 v61, v45
    v_exp_f32 v62, v46
    v_exp_f32 v63, v47
    v_add_u32 v112, 1024, v112
    v_add_u32 v113, 1024, v113
    v_add_u32 v114, 1024, v114
    v_pk_add_f32 v[48:49], v[48:49], s[58:59]
    v_pk_add_f32 v[50:51], v[50:51], s[58:59]
    v_pk_add_f32 v[52:53], v[52:53], s[58:59]
    v_pk_add_f32 v[54:55], v[54:55], s[58:59]
    v_pk_add_f32 v[56:57], v[56:57], s[58:59]
    v_pk_add_f32 v[58:59], v[58:59], s[58:59]
    v_pk_add_f32 v[60:61], v[60:61], s[58:59]
    v_pk_add_f32 v[62:63], v[62:63], s[58:59]
    v_rcp_f32 v48, v48
    v_rcp_f32 v49, v49
    v_rcp_f32 v50, v50
    v_rcp_f32 v51, v51
    v_rcp_f32 v52, v52
    v_rcp_f32 v53, v53
    v_rcp_f32 v54, v54
    v_rcp_f32 v55, v55
    v_rcp_f32 v56, v56
    v_rcp_f32 v57, v57
    v_rcp_f32 v58, v58
    v_rcp_f32 v59, v59
    v_rcp_f32 v60, v60
    v_rcp_f32 v61, v61
    v_rcp_f32 v62, v62
    v_rcp_f32 v63, v63
    s_nop 0
    v_pk_mul_f32 v[10:11], v[32:33], v[48:49]
    v_pk_fma_f32 v[10:11], v[34:35], v[50:51], v[10:11]
    v_pk_fma_f32 v[10:11], v[36:37], v[52:53], v[10:11]
    v_pk_fma_f32 v[10:11], v[38:39], v[54:55], v[10:11]
    v_pk_fma_f32 v[10:11], v[40:41], v[56:57], v[10:11]
    v_pk_fma_f32 v[10:11], v[42:43], v[58:59], v[10:11]
    v_pk_fma_f32 v[10:11], v[44:45], v[60:61], v[10:11]
    v_pk_fma_f32 v[10:11], v[46:47], v[62:63], v[10:11]
    v_cvt_f64_f32 v[12:13], v11
    v_cvt_f64_f32 v[10:11], v10
    ds_add_f64 v121, v[12:13] offset:896
    ds_add_f64 v120, v[10:11] offset:896
    s_branch K2_S_LOOP0
K2_S_TAIL0:
    v_mfma_f32_32x32x16_bf16 v[32:47], v[80:83], v[88:91], 0
    v_exp_f32 v48, v16
    v_exp_f32 v49, v17
    v_exp_f32 v50, v18
    v_exp_f32 v51, v19
    v_mfma_f32_32x32x16_bf16 v[32:47], v[72:75], v[92:95], v[32:47]
    v_exp_f32 v52, v20
    v_exp_f32 v53, v21
    v_exp_f32 v54, v22
    v_exp_f32 v55, v23
    v_mfma_f32_32x32x16_bf16 v[32:47], v[76:79], v[96:99], v[32:47]
    v_exp_f32 v56, v24
    v_exp_f32 v57, v25
    v_exp_f32 v58, v26
    v_exp_f32 v59, v27
    v_exp_f32 v60, v28
    v_exp_f32 v61, v29
    v_exp_f32 v62, v30
    v_exp_f32 v63, v31
    v_pk_add_f32 v[48:49], v[48:49], s[58:59]
    v_pk_add_f32 v[50:51], v[50:51], s[58:59]
    v_pk_add_f32 v[52:53], v[52:53], s[58:59]
    v_pk_add_f32 v[54:55], v[54:55], s[58:59]
    v_pk_add_f32 v[56:57], v[56:57], s[58:59]
    v_pk_add_f32 v[58:59], v[58:59], s[58:59]
    v_pk_add_f32 v[60:61], v[60:61], s[58:59]
    v_pk_add_f32 v[62:63], v[62:63], s[58:59]
    v_rcp_f32 v48, v48
    v_rcp_f32 v49, v49
    v_rcp_f32 v50, v50
    v_rcp_f32 v51, v51
    v_rcp_f32 v52, v52
    v_rcp_f32 v53, v53
    v_rcp_f32 v54, v54
    v_rcp_f32 v55, v55
    v_rcp_f32 v56, v56
    v_rcp_f32 v57, v57
    v_rcp_f32 v58, v58
    v_rcp_f32 v59, v59
    v_rcp_f32 v60, v60
    v_rcp_f32 v61, v61
    v_rcp_f32 v62, v62
    v_rcp_f32 v63, v63
    s_nop 0
    v_pk_mul_f32 v[10:11], v[16:17], v[48:49]
    v_pk_fma_f32 v[10:11], v[18:19], v[50:51], v[10:11]
    v_pk_fma_f32 v[10:11], v[20:21], v[52:53], v[10:11]
    v_pk_fma_f32 v[10:11], v[22:23], v[54:55], v[10:11]
    v_pk_fma_f32 v[10:11], v[24:25], v[56:57], v[10:11]
    v_pk_fma_f32 v[10:11], v[26:27], v[58:59], v[10:11]
    v_pk_fma_f32 v[10:11], v[28:29], v[60:61], v[10:11]
    v_pk_fma_f32 v[10:11], v[30:31], v[62:63], v[10:11]
    v_cvt_f64_f32 v[12:13], v11
    v_cvt_f64_f32 v[10:11], v10
    ds_add_f64 v119, v[12:13] offset:640
    ds_add_f64 v118, v[10:11] offset:640
    v_exp_f32 v48, v32
    v_exp_f32 v49, v33
    v_exp_f32 v50, v34
    v_exp_f32 v51, v35
    v_exp_f32 v52, v36
    v_exp_f32 v53, v37
    v_exp_f32 v54, v38
    v_exp_f32 v55, v39
    v_exp_f32 v56, v40
    v_exp_f32 v57, v41
    v_exp_f32 v58, v42
    v_exp_f32 v59, v43
    v_exp_f32 v60, v44
    v_exp_f32 v61, v45
    v_exp_f32 v62, v46
    v_exp_f32 v63, v47
    v_pk_add_f32 v[48:49], v[48:49], s[58:59]
    v_pk_add_f32 v[50:51], v[50:51], s[58:59]
    v_pk_add_f32 v[52:53], v[52:53], s[58:59]
    v_pk_add_f32 v[54:55], v[54:55], s[58:59]
    v_pk_add_f32 v[56:57], v[56:57], s[58:59]
    v_pk_add_f32 v[58:59], v[58:59], s[58:59]
    v_pk_add_f32 v[60:61], v[60:61], s[58:59]
    v_pk_add_f32 v[62:63], v[62:63], s[58:59]
    v_rcp_f32 v48, v48
    v_rcp_f32 v49, v49
    v_rcp_f32 v50, v50
    v_rcp_f32 v51, v51
    v_rcp_f32 v52, v52
    v_rcp_f32 v53, v53
    v_rcp_f32 v54, v54
    v_rcp_f32 v55, v55
    v_rcp_f32 v56, v56
    v_rcp_f32 v57, v57
    v_rcp_f32 v58, v58
    v_rcp_f32 v59, v59
    v_rcp_f32 v60, v60
    v_rcp_f32 v61, v61
    v_rcp_f32 v62, v62
    v_rcp_f32 v63, v63
    s_nop 0
    v_pk_mul_f32 v[10:11], v[32:33], v[48:49]
    v_pk_fma_f32 v[10:11], v[34:35], v[50:51], v[10:11]
    v_pk_fma_f32 v[10:11], v[36:37], v[52:53], v[10:11]
    v_pk_fma_f32 v[10:11], v[38:39], v[54:55], v[10:11]
    v_pk_fma_f32 v[10:11], v[40:41], v[56:57], v[10:11]
    v_pk_fma_f32 v[10:11], v[42:43], v[58:59], v[10:11]
    v_pk_fma_f32 v[10:11], v[44:45], v[60:61], v[10:11]
    v_pk_fma_f32 v[10:11], v[46:47], v[62:63], v[10:11]
    v_cvt_f64_f32 v[12:13], v11
    v_cvt_f64_f32 v[10:11], v10
    ds_add_f64 v119, v[12:13] offset:896
    ds_add_f64 v118, v[10:11] offset:896
    s_branch K2_LOOPDONE
K2_S_TAIL1:
    v_mfma_f32_32x32x16_bf16 v[32:47], v[80:83], v[88:91], 0
    v_exp_f32 v48, v16
    v_exp_f32 v49, v17
    v_exp_f32 v50, v18
    v_exp_f32 v51, v19
    v_mfma_f32_32x32x16_bf16 v[32:47], v[72:75], v[92:95], v[32:47]
    v_exp_f32 v52, v20
    v_exp_f32 v53, v21
    v_exp_f32 v54, v22
    v_exp_f32 v55, v23
    v_mfma_f32_32x32x16_bf16 v[32:47], v[76:79], v[96:99], v[32:47]
    v_exp_f32 v56, v24
    v_exp_f32 v57, v25
    v_exp_f32 v58, v26
    v_exp_f32 v59, v27
    v_exp_f32 v60, v28
    v_exp_f32 v61, v29
    v_exp_f32 v62, v30
    v_exp_f32 v63, v31
    v_pk_add_f32 v[48:49], v[48:49], s[58:59]
    v_pk_add_f32 v[50:51], v[50:51], s[58:59]
    v_pk_add_f32 v[52:53], v[52:53], s[58:59]
    v_pk_add_f32 v[54:55], v[54:55], s[58:59]
    v_pk_add_f32 v[56:57], v[56:57], s[58:59]
    v_pk_add_f32 v[58:59], v[58:59], s[58:59]
    v_pk_add_f32 v[60:61], v[60:61], s[58:59]
    v_pk_add_f32 v[62:63], v[62:63], s[58:59]
    v_rcp_f32 v48, v48
    v_rcp_f32 v49, v49
    v_rcp_f32 v50, v50
    v_rcp_f32 v51, v51
    v_rcp_f32 v52, v52
    v_rcp_f32 v53, v53
    v_rcp_f32 v54, v54
    v_rcp_f32 v55, v55
    v_rcp_f32 v56, v56
    v_rcp_f32 v57, v57
    v_rcp_f32 v58, v58
    v_rcp_f32 v59, v59
    v_rcp_f32 v60, v60
    v_rcp_f32 v61, v61
    v_rcp_f32 v62, v62
    v_rcp_f32 v63, v63
    s_nop 0
    v_pk_mul_f32 v[10:11], v[16:17], v[48:49]
    v_pk_fma_f32 v[10:11], v[18:19], v[50:51], v[10:11]
    v_pk_fma_f32 v[10:11], v[20:21], v[52:53], v[10:11]
    v_pk_fma_f32 v[10:11], v[22:23], v[54:55], v[10:11]
    v_pk_fma_f32 v[10:11], v[24:25], v[56:57], v[10:11]
    v_pk_fma_f32 v[10:11], v[26:27], v[58:59], v[10:11]
    v_pk_fma_f32 v[10:11], v[28:29], v[60:61], v[10:11]
    v_pk_fma_f32 v[10:11], v[30:31], v[62:63], v[10:11]
    v_cvt_f64_f32 v[12:13], v11
    v_cvt_f64_f32 v[10:11], v10
    ds_add_f64 v121, v[12:13] offset:640
    ds_add_f64 v120, v[10:11] offset:640
    v_exp_f32 v48, v32
    v_exp_f32 v49, v33
    v_exp_f32 v50, v34
    v_exp_f32 v51, v35
    v_exp_f32 v52, v36
    v_exp_f32 v53, v37
    v_exp_f32 v54, v38
    v_exp_f32 v55, v39
    v_exp_f32 v56, v40
    v_exp_f32 v57, v41
    v_exp_f32 v58, v42
    v_exp_f32 v59, v43
    v_exp_f32 v60, v44
    v_exp_f32 v61, v45
    v_exp_f32 v62, v46
    v_exp_f32 v63, v47
    v_pk_add_f32 v[48:49], v[48:49], s[58:59]
    v_pk_add_f32 v[50:51], v[50:51], s[58:59]
    v_pk_add_f32 v[52:53], v[52:53], s[58:59]
    v_pk_add_f32 v[54:55], v[54:55], s[58:59]
    v_pk_add_f32 v[56:57], v[56:57], s[58:59]
    v_pk_add_f32 v[58:59], v[58:59], s[58:59]
    v_pk_add_f32 v[60:61], v[60:61], s[58:59]
    v_pk_add_f32 v[62:63], v[62:63], s[58:59]
    v_rcp_f32 v48, v48
    v_rcp_f32 v49, v49
    v_rcp_f32 v50, v50
    v_rcp_f32 v51, v51
    v_rcp_f32 v52, v52
    v_rcp_f32 v53, v53
    v_rcp_f32 v54, v54
    v_rcp_f32 v55, v55
    v_rcp_f32 v56, v56
    v_rcp_f32 v57, v57
    v_rcp_f32 v58, v58
    v_rcp_f32 v59, v59
    v_rcp_f32 v60, v60
    v_rcp_f32 v61, v61
    v_rcp_f32 v62, v62
    v_rcp_f32 v63, v63
    s_nop 0
    v_pk_mul_f32 v[10:11], v[32:33], v[48:49]
    v_pk_fma_f32 v[10:11], v[34:35], v[50:51], v[10:11]
    v_pk_fma_f32 v[10:11], v[36:37], v[52:53], v[10:11]
    v_pk_fma_f32 v[10:11], v[38:39], v[54:55], v[10:11]
    v_pk_fma_f32 v[10:11], v[40:41], v[56:57], v[10:11]
    v_pk_fma_f32 v[10:11], v[42:43], v[58:59], v[10:11]
    v_pk_fma_f32 v[10:11], v[44:45], v[60:61], v[10:11]
    v_pk_fma_f32 v[10:11], v[46:47], v[62:63], v[10:11]
    v_cvt_f64_f32 v[12:13], v11
    v_cvt_f64_f32 v[10:11], v10
    ds_add_f64 v121, v[12:13] offset:896
    ds_add_f64 v120, v[10:11] offset:896
    s_branch K2_LOOPDONE
K2_CORRADD:
    ds_add_f64 v6, v[32:33] offset:640
    ds_add_f64 v6, v[34:35] offset:648
    ds_add_f64 v6, v[36:37] offset:656
    ds_add_f64 v6, v[38:39] offset:664
    ds_add_f64 v6, v[40:41] offset:768
    ds_add_f64 v6, v[42:43] offset:776
    ds_add_f64 v6, v[44:45] offset:784
    ds_add_f64 v6, v[46:47] offset:792
    ds_add_f64 v6, v[48:49] offset:896
    ds_add_f64 v6, v[50:51] offset:904
    ds_add_f64 v6, v[52:53] offset:912
    ds_add_f64 v6, v[54:55] offset:920
    ds_add_f64 v6, v[56:57] offset:1024
    ds_add_f64 v6, v[58:59] offset:1032
    ds_add_f64 v6, v[60:61] offset:1040
    ds_add_f64 v6, v[62:63] offset:1048
    s_waitcnt lgkmcnt(0)
    s_branch K2_CORRDONE
K2_NOTINIT:
    ds_read_b32 v122, v125
    s_waitcnt lgkmcnt(0)
    v_readfirstlane_b32 s3, v122
    s_cmp_lt_u32 s3, 4
    s_cbranch_scc1 K2_NOTINIT
    s_branch K2_INITOK
K2_SLOWHEAD:
    v_mov_b32 v104, -1
    v_mov_b32 v106, -1
    v_mov_b32 v108, -1
    v_mov_b32 v110, -1
    v_mov_b32 v2, 632
    ds_read_b64 v[4:5], v2
    s_waitcnt lgkmcnt(0)
    v_readfirstlane_b32 s26, v4
    v_readfirstlane_b32 s52, v5
    s_lshl_b32 s3, s25, 2
    s_add_u32 s3, s3, s46
    s_sub_i32 s48, s26, s3
    s_add_i32 s48, s48, 15
    s_max_i32 s48, s48, 0
    s_lshr_b32 s48, s48, 4
    s_sub_i32 s3, s26, s46
    s_add_i32 s3, s3, 15
    s_max_i32 s3, s3, 0
    s_lshr_b32 s3, s3, 2
    s_min_u32 s3, s3, s25
    s_mul_i32 s3, s3, s27
    s_add_u32 s48, s48, s3
    s_branch K2_DYNHEAD
K2_CAREFUL:
    s_mov_b64 exec, s[60:61]
    v_mul_u32_u24 v48, 0x5556, v48
    v_lshrrev_b32 v48, 18, v48
    v_mul_u32_u24 v48, 112, v48
    v_add_u32 v48, 13472, v48
    v_add_u32 v60, v60, v20
    v_cmpx_lt_u32 vcc, v60, v48
    v_lshlrev_b32 v60, 2, v60
    s_andn2_b64 s[60:61], s[60:61], vcc
    ds_write_b32 v60, v32
    s_mov_b64 exec, s[62:63]
    v_mul_u32_u24 v49, 0x5556, v49
    v_lshrrev_b32 v49, 18, v49
    v_mul_u32_u24 v49, 112, v49
    v_add_u32 v49, 13472, v49
    v_add_u32 v61, v61, v21
    v_cmpx_lt_u32 vcc, v61, v49
    v_lshlrev_b32 v61, 2, v61
    s_andn2_b64 s[62:63], s[62:63], vcc
    ds_write_b32 v61, v33
    s_mov_b64 exec, s[64:65]
    v_mul_u32_u24 v50, 0x5556, v50
    v_lshrrev_b32 v50, 18, v50
    v_mul_u32_u24 v50, 112, v50
    v_add_u32 v50, 13472, v50
    v_add_u32 v62, v62, v22
    v_cmpx_lt_u32 vcc, v62, v50
    v_lshlrev_b32 v62, 2, v62
    s_andn2_b64 s[64:65], s[64:65], vcc
    ds_write_b32 v62, v34
    s_mov_b64 exec, s[66:67]
    v_mul_u32_u24 v51, 0x5556, v51
    v_lshrrev_b32 v51, 18, v51
    v_mul_u32_u24 v51, 112, v51
    v_add_u32 v51, 13472, v51
    v_add_u32 v63, v63, v23
    v_cmpx_lt_u32 vcc, v63, v51
    v_lshlrev_b32 v63, 2, v63
    s_andn2_b64 s[66:67], s[66:67], vcc
    ds_write_b32 v63, v35
    s_mov_b64 exec, s[68:69]
    v_mul_u32_u24 v52, 0x5556, v52
    v_lshrrev_b32 v52, 18, v52
    v_mul_u32_u24 v52, 112, v52
    v_add_u32 v52, 13472, v52
    v_add_u32 v64, v64, v24
    v_cmpx_lt_u32 vcc, v64, v52
    v_lshlrev_b32 v64, 2, v64
    s_andn2_b64 s[68:69], s[68:69], vcc
    ds_write_b32 v64, v36
    s_mov_b64 exec, s[70:71]
    v_mul_u32_u24 v53, 0x5556, v53
    v_lshrrev_b32 v53, 18, v53
    v_mul_u32_u24 v53, 112, v53
    v_add_u32 v53, 13472, v53
    v_add_u32 v65, v65, v25
    v_cmpx_lt_u32 vcc, v65, v53
    v_lshlrev_b32 v65, 2, v65
    s_andn2_b64 s[70:71], s[70:71], vcc
    ds_write_b32 v65, v37
    s_mov_b64 exec, s[72:73]
    v_mul_u32_u24 v54, 0x5556, v54
    v_lshrrev_b32 v54, 18, v54
    v_mul_u32_u24 v54, 112, v54
    v_add_u32 v54, 13472, v54
    v_add_u32 v66, v66, v26
    v_cmpx_lt_u32 vcc, v66, v54
    v_lshlrev_b32 v66, 2, v66
    s_andn2_b64 s[72:73], s[72:73], vcc
    ds_write_b32 v66, v38
    s_mov_b64 exec, s[74:75]
    v_mul_u32_u24 v55, 0x5556, v55
    v_lshrrev_b32 v55, 18, v55
    v_mul_u32_u24 v55, 112, v55
    v_add_u32 v55, 13472, v55
    v_add_u32 v67, v67, v27
    v_cmpx_lt_u32 vcc, v67, v55
    v_lshlrev_b32 v67, 2, v67
    s_andn2_b64 s[74:75], s[74:75], vcc
    ds_write_b32 v67, v39
    s_mov_b64 exec, s[76:77]
    v_mul_u32_u24 v56, 0x5556, v56
    v_lshrrev_b32 v56, 18, v56
    v_mul_u32_u24 v56, 112, v56
    v_add_u32 v56, 13472, v56
    v_add_u32 v68, v68, v28
    v_cmpx_lt_u32 vcc, v68, v56
    v_lshlrev_b32 v68, 2, v68
    s_andn2_b64 s[76:77], s[76:77], vcc
    ds_write_b32 v68, v40
    s_mov_b64 exec, s[78:79]
    v_mul_u32_u24 v57, 0x5556, v57
    v_lshrrev_b32 v57, 18, v57
    v_mul_u32_u24 v57, 112, v57
    v_add_u32 v57, 13472, v57
    v_add_u32 v69, v69, v29
    v_cmpx_lt_u32 vcc, v69, v57
    v_lshlrev_b32 v69, 2, v69
    s_andn2_b64 s[78:79], s[78:79], vcc
    ds_write_b32 v69, v41
    s_mov_b64 exec, s[80:81]
    v_mul_u32_u24 v58, 0x5556, v58
    v_lshrrev_b32 v58, 18, v58
    v_mul_u32_u24 v58, 112, v58
    v_add_u32 v58, 13472, v58
    v_add_u32 v70, v70, v30
    v_cmpx_lt_u32 vcc, v70, v58
    v_lshlrev_b32 v70, 2, v70
    s_andn2_b64 s[80:81], s[80:81], vcc
    ds_write_b32 v70, v42
    s_mov_b64 exec, s[82:83]
    v_mul_u32_u24 v59, 0x5556, v59
    v_lshrrev_b32 v59, 18, v59
    v_mul_u32_u24 v59, 112, v59
    v_add_u32 v59, 13472, v59
    v_add_u32 v71, v71, v31
    v_cmpx_lt_u32 vcc, v71, v59
    v_lshlrev_b32 v71, 2, v71
    s_andn2_b64 s[82:83], s[82:83], vcc
    ds_write_b32 v71, v43
    s_branch K2_PL4
K2_GOSLOW:
    s_mov_b32 s51, 1
    s_mov_b32 s50, -36
    s_mov_b32 s24, 0
    s_mov_b32 s25, 0
    s_waitcnt lgkmcnt(0)
    s_barrier
    s_cmp_eq_u32 s27, 0
    s_cbranch_scc1 K2_NEXTCHUNK
    v_subrev_u32 v2, 768, v0
    v_lshlrev_b32 v2, 4, v2
    v_mov_b32 v4, 0xffff
    v_mov_b32 v5, 0xffff
    v_mov_b32 v6, 0xffff
    v_mov_b32 v7, 0xffff
    ds_write_b128 v2, v[4:7] offset:53440
    ds_write_b128 v2, v[4:7] offset:57536
    ds_write_b128 v2, v[4:7] offset:61632
    v_add_u32 v3, 53440, v2
    ds_write_b128 v3, v[4:7] offset:12288
    ds_write_b128 v3, v[4:7] offset:16384
    v_mov_b32 v8, 1920
    v_cmpx_lt_u32 vcc, v2, v8
    ds_write_b128 v3, v[4:7] offset:20480
    s_mov_b64 exec, -1
    v_mov_b32 v4, 0
    v_mov_b32 v5, 0
    v_mov_b32 v6, 0
    v_mov_b32 v7, 0
    ds_write_b128 v2, v[4:7] offset:640
    ds_write_b128 v2, v[4:7] offset:4736
    ds_write_b128 v2, v[4:7] offset:8832
    ds_write_b128 v2, v[4:7] offset:12928
    ds_write_b128 v2, v[4:7] offset:17024
    ds_write_b128 v2, v[4:7] offset:21120
    v_mov_b32 v8, 1824
    v_cmpx_lt_u32 vcc, v2, v8
    ds_write_b128 v2, v[4:7] offset:25216
    s_mov_b64 exec, -1
    v_mov_b32 v4, 0
    v_mov_b32 v5, 0
    v_mov_b32 v6, 0
    v_mov_b32 v7, 0
    v_mul_u32_u24 v3, 12, v1
    v_mul_u32_u24 v8, 112, v1
    v_add_u32 v8, 13360, v8
    s_mov_b32 exec_lo, -1
    s_mov_b32 exec_hi, 0x3ffff
    ds_write2_b32 v3, v4, v8 offset0:4 offset1:5
    ds_write_b32 v3, v4 offset:24
    s_mov_b64 exec, -1
    s_branch K2_HAGAIN
K2_NEXTCHUNK:
    s_add_u32 s50, s50, 36
    s_cmp_lg_u32 s27, 0
    s_cbranch_scc1 K2_RETRY
    v_mul_u32_u24 v3, 0x5556, v0
    v_lshrrev_b32 v4, 16, v3
    v_and_b32 v3, 31, v4
    v_lshrrev_b32 v12, 5, v4
    v_lshl_add_u32 v12, v3, 3, v12
    v_mul_u32_u24 v3, 3, v4
    v_sub_u32 v3, v0, v3
    v_lshlrev_b32 v3, 2, v3
    v_add_u32 v3, s50, v3
    v_mul_u32_u24 v4, 4224, v12
    v_lshrrev_b32 v5, 16, v127
    v_sub_u32 v2, v5, v3
    v_cmp_lt_i32 s[60:61], 0, v2
    v_cmp_lt_i32 s[68:69], 12, v2
    v_cmp_lt_i32 s[76:77], 24, v2
    v_cmp_lt_i32 s[62:63], 1, v2
    v_cmp_lt_i32 s[64:65], 2, v2
    v_cmp_lt_i32 s[66:67], 3, v2
    v_cmp_lt_i32 s[70:71], 13, v2
    v_cmp_lt_i32 s[72:73], 14, v2
    v_cmp_lt_i32 s[74:75], 15, v2
    v_cmp_lt_i32 s[78:79], 25, v2
    v_cmp_lt_i32 s[80:81], 26, v2
    v_cmp_lt_i32 s[82:83], 27, v2
K2_RETRY:
    s_mov_b32 s55, 1
    s_waitcnt lgkmcnt(0)
    s_cmp_lg_u32 s27, 0
    s_cbranch_scc1 K2_HRETRY
    v_mul_u32_u24 v3, 0x5556, v0
    v_lshrrev_b32 v4, 16, v3
    v_and_b32 v3, 31, v4
    v_lshrrev_b32 v12, 5, v4
    v_lshl_add_u32 v12, v3, 3, v12
    v_mul_u32_u24 v3, 3, v4
    v_sub_u32 v3, v0, v3
    v_lshlrev_b32 v3, 2, v3
    v_add_u32 v3, s50, v3
    v_mul_u32_u24 v4, 4224, v12
    v_and_b32 v6, 0xffff, v127
    v_lshrrev_b32 v5, 16, v127
    v_add_u32 v4, v6, v4
    v_add_lshl_u32 v5, v4, v5, 2
    v_add_lshl_u32 v4, v4, v3, 2
    v_add_u32 v5, v5, v3
    s_or_b64 s[84:85], s[60:61], s[62:63]
    s_or_b64 s[84:85], s[84:85], s[64:65]
    s_or_b64 exec, s[84:85], s[66:67]
    buffer_load_dword v44, v5, s[40:43], 0 offen offset:0
    buffer_load_dwordx4 v[32:35], v4, s[40:43], 0 offen offset:0
    s_or_b64 s[84:85], s[68:69], s[70:71]
    s_or_b64 s[84:85], s[84:85], s[72:73]
    s_or_b64 exec, s[84:85], s[74:75]
    buffer_load_dword v45, v5, s[40:43], 0 offen offset:12
    buffer_load_dwordx4 v[36:39], v4, s[40:43], 0 offen offset:48
    s_or_b64 s[84:85], s[76:77], s[78:79]
    s_or_b64 s[84:85], s[84:85], s[80:81]
    s_or_b64 exec, s[84:85], s[82:83]
    s_cbranch_scc0 K2_RL2
    buffer_load_dword v46, v5, s[40:43], 0 offen offset:24
    buffer_load_dwordx4 v[40:43], v4, s[40:43], 0 offen offset:96
K2_RL2:
    s_mov_b64 exec, -1
    v_lshrrev_b32 v8, 4, v1
    v_lshl_add_u32 v8, s46, 2, v8
    v_mul_u32_u24 v9, 448, v8
    v_lshlrev_b32 v11, 1, v1
    v_and_b32 v11, 16, v11
    v_add3_u32 v12, v9, v11, s7
    v_bfe_u32 v8, v1, 4, 1
    v_lshrrev_b32 v9, 5, v1
    v_lshl_or_b32 v8, v9, 2, v8
    v_and_b32 v9, 7, v1
    v_xor_b32 v8, v8, v9
    v_lshlrev_b32 v105, 4, v8
    v_xor_b32 v107, 32, v105
    v_mov_b32 v109, v105
    v_mov_b32 v111, v107
    v_bfrev_b32 v17, 1
    s_barrier
    s_branch K2_PASS
K2_HAGAIN:
    s_mov_b32 s55, 1
    s_add_u32 s50, s50, 36
    s_branch K2_HR2
K2_HRETRY:
    v_subrev_u32 v2, 768, v0
    v_lshlrev_b32 v2, 4, v2
    v_mov_b32 v4, 0xffff
    v_mov_b32 v5, 0xffff
    v_mov_b32 v6, 0xffff
    v_mov_b32 v7, 0xffff
    ds_write_b128 v2, v[4:7] offset:53440
    ds_write_b128 v2, v[4:7] offset:57536
    ds_write_b128 v2, v[4:7] offset:61632
    v_add_u32 v3, 53440, v2
    ds_write_b128 v3, v[4:7] offset:12288
    ds_write_b128 v3, v[4:7] offset:16384
    v_mov_b32 v8, 1920
    v_cmpx_lt_u32 vcc, v2, v8
    ds_write_b128 v3, v[4:7] offset:20480
    s_mov_b64 exec, -1
    v_mov_b32 v4, 0
    v_mov_b32 v5, 0
    v_mov_b32 v6, 0
    v_mov_b32 v7, 0
    v_mov_b32 v4, 0
    v_mov_b32 v5, 0
    v_mov_b32 v6, 0
    v_mov_b32 v7, 0
    v_mul_u32_u24 v3, 12, v1
    v_mul_u32_u24 v8, 112, v1
    v_add_u32 v8, 13360, v8
    s_mov_b32 exec_lo, -1
    s_mov_b32 exec_hi, 0x3ffff
    ds_write2_b32 v3, v4, v8 offset0:4 offset1:5
    ds_write_b32 v3, v4 offset:24
    s_mov_b64 exec, -1
K2_HR2:
    v_lshrrev_b32 v8, 4, v1
    v_lshl_add_u32 v8, s46, 2, v8
    v_mul_u32_u24 v9, 448, v8
    v_lshlrev_b32 v11, 1, v1
    v_and_b32 v11, 16, v11
    v_add3_u32 v12, v9, v11, s7
    v_bfe_u32 v8, v1, 4, 1
    v_lshrrev_b32 v9, 5, v1
    v_lshl_or_b32 v8, v9, 2, v8
    v_and_b32 v9, 7, v1
    v_xor_b32 v8, v8, v9
    v_lshlrev_b32 v105, 4, v8
    v_xor_b32 v107, 32, v105
    v_mov_b32 v109, v105
    v_mov_b32 v111, v107
    v_mov_b32 v104, -1
    v_mov_b32 v106, -1
    v_mov_b32 v108, -1
    v_mov_b32 v110, -1
    v_min_u32 v12, 48, v1
    v_mul_u32_u24 v13, 12, v12
    v_cmp_gt_u32 s[84:85], 48, v1
    v_mul_u32_u24 v27, 528, v12
    v_mul_u32_u24 v26, 448, v12
    v_lshrrev_b32 v28, 2, v26
    v_add_u32 v28, 13360, v28
    v_subrev_u32 v29, 48, v1
    v_mov_b32 v11, s24
    v_cndmask_b32 v12, v29, v11, s[84:85]
    v_cndmask_b32 v24, 1, 14, s[84:85]
    v_lshl_add_u32 v26, v12, 5, v26
    v_add_u32 v26, s7, v26
    s_lshl_b32 s60, s25, 4
    s_mul_i32 s61, s25, 384
    s_add_u32 s61, s61, 75840
    v_lshrrev_b32 v7, 4, v1
    v_and_b32 v25, 15, v1
    s_lshl_b32 s3, s53, 4
    v_add_u32 v25, s3, v25
    v_mul_u32_u24 v6, 528, v25
    v_lshl_add_u32 v6, v7, 5, v6
    v_mul_u32_u24 v10, 12, v25
    v_cmp_gt_u32 s[86:87], 50, v25
    v_lshlrev_b32 v3, 4, v1
    v_add_u32 v14, 81472, v3
    v_add_u32 v2, 27040, v6
    ds_read2_b32 v[32:33], v2 offset0:0 offset1:2
    ds_read2_b32 v[34:35], v2 offset0:4 offset1:6
    ds_read2_b32 v[36:37], v2 offset0:32 offset1:34
    ds_read2_b32 v[38:39], v2 offset0:36 offset1:38
    ds_read2_b32 v[40:41], v2 offset0:64 offset1:66
    ds_read2_b32 v[42:43], v2 offset0:68 offset1:70
    ds_read2_b32 v[44:45], v2 offset0:96 offset1:98
    ds_read2_b32 v[46:47], v2 offset0:100 offset1:102
    s_waitcnt lgkmcnt(0)
    s_barrier
    v_lshlrev_b32 v64, 16, v32
    v_and_b32 v32, 0xffff0000, v32
    v_add_f32 v64, v64, v32
    v_lshlrev_b32 v65, 16, v33
    v_and_b32 v33, 0xffff0000, v33
    v_add_f32 v65, v65, v33
    v_lshlrev_b32 v66, 16, v34
    v_and_b32 v34, 0xffff0000, v34
    v_add_f32 v66, v66, v34
    v_lshlrev_b32 v67, 16, v35
    v_and_b32 v35, 0xffff0000, v35
    v_add_f32 v67, v67, v35
    v_lshlrev_b32 v68, 16, v36
    v_and_b32 v36, 0xffff0000, v36
    v_add_f32 v68, v68, v36
    v_lshlrev_b32 v69, 16, v37
    v_and_b32 v37, 0xffff0000, v37
    v_add_f32 v69, v69, v37
    v_lshlrev_b32 v70, 16, v38
    v_and_b32 v38, 0xffff0000, v38
    v_add_f32 v70, v70, v38
    v_lshlrev_b32 v71, 16, v39
    v_and_b32 v39, 0xffff0000, v39
    v_add_f32 v71, v71, v39
    v_lshlrev_b32 v72, 16, v40
    v_and_b32 v40, 0xffff0000, v40
    v_add_f32 v72, v72, v40
    v_lshlrev_b32 v73, 16, v41
    v_and_b32 v41, 0xffff0000, v41
    v_add_f32 v73, v73, v41
    v_lshlrev_b32 v74, 16, v42
    v_and_b32 v42, 0xffff0000, v42
    v_add_f32 v74, v74, v42
    v_lshlrev_b32 v75, 16, v43
    v_and_b32 v43, 0xffff0000, v43
    v_add_f32 v75, v75, v43
    v_lshlrev_b32 v76, 16, v44
    v_and_b32 v44, 0xffff0000, v44
    v_add_f32 v76, v76, v44
    v_lshlrev_b32 v77, 16, v45
    v_and_b32 v45, 0xffff0000, v45
    v_add_f32 v77, v77, v45
    v_lshlrev_b32 v78, 16, v46
    v_and_b32 v46, 0xffff0000, v46
    v_add_f32 v78, v78, v46
    v_lshlrev_b32 v79, 16, v47
    v_and_b32 v47, 0xffff0000, v47
    v_add_f32 v79, v79, v47
    s_branch K2_HPASS2
.section .rodata,"a"
.p2align 6
.amdhsa_kernel k1_kernel
  .amdhsa_next_free_vgpr 128
  .amdhsa_next_free_sgpr 102
  .amdhsa_accum_offset 128
  .amdhsa_group_segment_fixed_size 0
  .amdhsa_kernarg_size 72
  .amdhsa_user_sgpr_count 2
  .amdhsa_user_sgpr_kernarg_segment_ptr 1
  .amdhsa_system_sgpr_workgroup_id_x 1
.end_amdhsa_kernel
.p2align 6
.amdhsa_kernel k2_kernel
  .amdhsa_next_free_vgpr 128
  .amdhsa_next_free_sgpr 102
  .amdhsa_accum_offset 128
  .amdhsa_group_segment_fixed_size 0
  .amdhsa_kernarg_size 72
  .amdhsa_user_sgpr_count 2
  .amdhsa_user_sgpr_kernarg_segment_ptr 1
  .amdhsa_system_sgpr_workgroup_id_x 1
.end_amdhsa_kernel
```
